```python
import torch

def _softmax(x, axis=-1):
    return torch.softmax(x, dim=axis)
def _gelu(x):
    return torch.nn.functional.gelu(x, approximate="tanh")
def _silu(x):
    return torch.nn.functional.silu(x)
def _sigmoid(x):
    return torch.sigmoid(x)
def _layernorm(x, axis=-1, eps=1e-5):
    m = x.mean(dim=axis, keepdim=True)
    v = x.var(dim=axis, keepdim=True, unbiased=False)
    return (x - m) / torch.sqrt(v + eps)
def _scatter_add(tgt, idx, src, axis=0):
    return tgt.clone().index_add_(axis, idx, src)
def _segment_sum(src, seg, n):
    out = torch.zeros((n,) + src.shape[1:], dtype=src.dtype)
    return out.index_add_(0, seg, src)
def _pad(x, pw):
    flat = tuple(v for pair in reversed(pw) for v in pair)
    return torch.nn.functional.pad(x, flat)

kernel_name = 'interleave_layers__sliding_block_cached__glu_gated_reglu__decode'

def setup_inputs():

    _w = (lambda a: (lambda t: t.to(torch.bfloat16) if t.is_floating_point() else t)(torch.as_tensor(a)))
    def _A_setup():
        B, Sq, D = 4, 1, 512
        Hq, Hkv, Sk, Dh = 32, 8, 16384, 128
        assert Hq % Hkv == 0, (Hq, Hkv)
        return {
            "x": _w((lambda *s: torch.randn(*s, dtype=torch.bfloat16) * 0.05)(B, Sq, D)),
            "k_cache": _w((lambda *s: torch.randn(*s, dtype=torch.bfloat16) * 0.8)(B, Hkv, Sk, Dh)),
            "v_cache": _w((lambda *s: torch.randn(*s, dtype=torch.bfloat16) * 0.8)(B, Hkv, Sk, Dh)),
            "wq": _w((lambda *s: torch.randn(*s, dtype=torch.bfloat16) * 0.8)(D, Hq * Dh) * (D ** -0.5)),
            "wo": _w((lambda *s: torch.randn(*s, dtype=torch.bfloat16) * 0.8)(Hq * Dh, D) * ((Hq * Dh) ** -0.5)),
        }
    _A_in = _A_setup()

    def _B_setup():
        B, S, D, F = 4, 1, 512, 1792
        return {
            "x": _w((lambda *s: torch.randn(*s, dtype=torch.bfloat16) * 0.05)(B, S, D)),
            "W_gate": _w((lambda *s: torch.randn(*s, dtype=torch.bfloat16) * 0.2)(D, F) * (2.0 / D) ** 0.5),
            "W_up": _w((lambda *s: torch.randn(*s, dtype=torch.bfloat16) * 0.2)(D, F) * (2.0 / D) ** 0.5),
            "W_down": _w((lambda *s: torch.randn(*s, dtype=torch.bfloat16) * 0.2)(F, D) * (1.0 / F) ** 0.5),
        }
    _B_in = _B_setup()

    return {
        "A_x": _A_in["x"],
        "A_k_cache": _A_in["k_cache"],
        "A_v_cache": _A_in["v_cache"],
        "A_wq": _A_in["wq"],
        "A_wo": _A_in["wo"],
        "B_x": _B_in["x"],
        "B_W_gate": _B_in["W_gate"],
        "B_W_up": _B_in["W_up"],
        "B_W_down": _B_in["W_down"],
    }

def reference(A_x, A_k_cache, A_v_cache, A_wq, A_wo, B_x, B_W_gate, B_W_up, B_W_down):
    def _A_ref(x, k_cache, v_cache, wq, wo):
        B, Sq, D = x.shape
        Hq, Dh = 32, 128
        Hkv, Sk = k_cache.shape[1], k_cache.shape[2]
        W = min(4096, max(256, Sk // 4))
        rep = Hq // Hkv
        q = (lambda x, *d: x.permute(*d))((x @ wq).reshape(B, Sq, Hq, Dh), 0, 2, 1, 3)
        k = (lambda x, n, axis: torch.repeat_interleave(x, n, dim=axis))(k_cache[:, :, Sk - W:, :], rep, axis=1)
        v = (lambda x, n, axis: torch.repeat_interleave(x, n, dim=axis))(v_cache[:, :, Sk - W:, :], rep, axis=1)
        scores = torch.einsum("bhqd,bhkd->bhqk", q, k) * (Dh ** -0.5)
        p = _softmax(scores, axis=-1)
        o = torch.einsum("bhqk,bhkd->bhqd", p, v)
        return (lambda x, *d: x.permute(*d))(o, 0, 2, 1, 3).reshape(B, Sq, Hq * Dh) @ wo

    def _B_ref(x, W_gate, W_up, W_down):
        gate = torch.einsum("bsd,df->bsf", x, W_gate)
        up = torch.einsum("bsd,df->bsf", x, W_up)
        gate = gate * (lambda x, dt: x.to(dt))(gate > 0, gate.dtype)
        h = gate * up
        return torch.einsum("bsf,fd->bsd", h, W_down)

    x = A_x
    x = x + _A_ref(_layernorm(x, axis=-1), A_k_cache, A_v_cache, A_wq, A_wo)
    x = x + _B_ref(_layernorm(x, axis=-1), B_W_gate, B_W_up, B_W_down)
    x = x + _A_ref(_layernorm(x, axis=-1), A_k_cache, A_v_cache, A_wq, A_wo)
    x = x + _B_ref(_layernorm(x, axis=-1), B_W_gate, B_W_up, B_W_down)
    return x
```

```asm
; @launch grid=(256,1,1) block=(512,1,1) lds=163840
.amdgcn_target "amdgcn-amd-amdhsa--gfx950"
.text
.globl interleave_layers__sliding_block_cached__glu_gated_reglu__decode_kernel
.p2align 8
.type interleave_layers__sliding_block_cached__glu_gated_reglu__decode_kernel,@function
interleave_layers__sliding_block_cached__glu_gated_reglu__decode_kernel:
    s_cmp_ge_u32 s2, 256
    s_cbranch_scc1 L_end
    s_load_dwordx8 s[4:11], s[0:1], 0
    s_load_dwordx4 s[24:27], s[0:1], 80
    v_lshrrev_b32 v2, 6, v0
    v_and_b32 v1, 63, v0
    v_readfirstlane_b32 s79, v2
    s_and_b32 s60, s2, 7
    s_lshr_b32 s61, s2, 3
    s_lshr_b32 s62, s2, 6
    v_lshrrev_b32 v12, 4, v1
    v_and_b32 v13, 15, v1
    s_and_b32 s63, s79, 3
    s_cmp_lt_u32 s79, 4
    s_cbranch_scc0 L_B
    v_xor_b32 v14, v13, v12
    v_lshlrev_b32 v14, 4, v14
    v_lshl_add_u32 v2, v12, 8, v14
    s_lshl3_add_u32 s66, s62, s60
    s_lshl_b32 s66, s66, 5
    s_and_b32 s67, s61, 7
    s_add_u32 s66, s66, s67
    s_add_u32 s66, s66, 24
    s_lshl_b32 s66, s66, 17
    s_mul_i32 s45, s2, 37
    s_add_u32 s45, s45, s63
    s_and_b32 s45, s45, 127
    s_lshl_b32 s45, s45, 10
    s_lshl_b32 s46, s63, 15
    s_mov_b32 s34, 0x20000
    s_mov_b32 s35, s34
    v_xor_b32 v3, 64, v2
    s_waitcnt lgkmcnt(0)
    s_add_u32 s32, s6, s66
    s_addc_u32 s33, s7, 0
    s_add_u32 m0, s46, 0
    s_mov_b32 s44, s45
    buffer_load_dwordx4 v2, s[32:35], s44 offen nt lds
    s_add_u32 m0, s46, 1024
    s_add_u32 s44, s44, 4096
    s_and_b32 s44, s44, 0x1ffff
    buffer_load_dwordx4 v3, s[32:35], s44 offen nt lds
    v_xor_b32 v4, 128, v2
    v_xor_b32 v5, 192, v2
    s_add_u32 m0, s46, 2048
    s_add_u32 s44, s44, 4096
    s_and_b32 s44, s44, 0x1ffff
    buffer_load_dwordx4 v4, s[32:35], s44 offen nt lds
    s_add_u32 m0, s46, 3072
    s_add_u32 s44, s44, 4096
    s_and_b32 s44, s44, 0x1ffff
    buffer_load_dwordx4 v5, s[32:35], s44 offen nt lds
    v_lshlrev_b32 v14, 1, v12
    v_xor_b32 v14, v13, v14
    v_lshlrev_b32 v14, 4, v14
    v_lshl_add_u32 v6, v12, 8, v14
    v_xor_b32 v7, 128, v6
    s_add_u32 s36, s8, s66
    s_addc_u32 s37, s9, 0
    s_mov_b32 s38, 131072
    s_mov_b32 s39, 0x20000
    s_load_dword s64, s[26:27], 0
    s_add_u32 m0, s46, 4096
    s_add_u32 s44, s44, 4096
    s_and_b32 s44, s44, 0x1ffff
    buffer_load_dwordx4 v2, s[32:35], s44 offen nt lds
    s_add_u32 m0, s46, 5120
    s_add_u32 s44, s44, 4096
    s_and_b32 s44, s44, 0x1ffff
    buffer_load_dwordx4 v3, s[32:35], s44 offen nt lds
    v_xor_b32 v14, v12, v13
    v_lshlrev_b32 v14, 4, v14
    v_lshl_add_u32 v8, v13, 8, v14
    v_add_u32 v8, s46, v8
    v_xor_b32 v9, 64, v8
    v_xor_b32 v10, 128, v8
    v_xor_b32 v11, 192, v8
    s_mov_b32 s28, s26
    s_mov_b32 s29, s27
    s_mov_b32 s30, 6291456
    s_mov_b32 s31, 0x20000
    s_mul_i32 s72, s60, 135168
    s_add_u32 s72, s72, 1310720
    s_add_u32 s73, s72, 67584
    s_mul_i32 s75, s60, 81920
    s_add_u32 s75, s75, 524288
    s_lshl_b32 s76, s60, 12
    s_add_u32 s76, s76, 65536
    s_lshl_b32 s77, s60, 10
    s_add_u32 s77, s77, 131072
    s_add_u32 s80, s60, 0
    s_and_b32 s80, s80, 3
    s_lshl_b32 s80, s80, 11
    s_add_u32 s80, s80, 4194304
    s_add_u32 s81, s60, 1
    s_and_b32 s81, s81, 3
    s_lshl_b32 s81, s81, 11
    s_add_u32 s81, s81, 4194304
    s_add_u32 s82, s60, 2
    s_and_b32 s82, s82, 3
    s_lshl_b32 s82, s82, 11
    s_add_u32 s82, s82, 4194304
    s_add_u32 s83, s60, 3
    s_and_b32 s83, s83, 3
    s_lshl_b32 s83, s83, 11
    s_add_u32 s83, s83, 4194304
    s_mov_b32 s78, 0xffffff00
    s_mov_b32 s74, 0xfffefffe
    s_mov_b32 s94, 0xfffff000
    s_mov_b32 s88, 0xf000f
    s_mov_b32 s89, 0xf000f
    v_lshrrev_b32 v16, 2, v1
    v_and_b32 v17, 7, v16
    v_lshlrev_b32 v17, 1, v17
    v_bfe_u32 v18, v1, 1, 1
    s_lshl_b32 s66, s63, 2
    v_add_u32 v18, s66, v18
    v_xor_b32 v18, v18, v17
    v_lshlrev_b32 v18, 4, v18
    v_lshl_add_u32 v18, v16, 8, v18
    v_and_b32 v19, 1, v1
    v_lshl_add_u32 v112, v19, 3, v18
    v_xor_b32 v113, 32, v112
    v_add_u32 v114, 0x10000, v112
    v_add_u32 v115, 0x10000, v113
    s_lshl_b32 s66, s63, 10
    s_add_u32 s66, s66, 155648
    v_lshl_add_u32 v116, v1, 4, s66
    v_and_b32 v19, 3, v1
    v_lshl_add_u32 v17, v12, 4, v19
    v_lshlrev_b32 v17, 4, v17
    v_add_u32 v117, 155648, v17
    v_lshlrev_b32 v17, 3, v1
    v_add_u32 v118, 161792, v17
    v_lshlrev_b32 v17, 4, v19
    v_lshl_add_u32 v119, v12, 6, v17
    s_and_b32 s68, s63, 1
    s_lshl_b32 s66, s68, 6
    v_add_u32 v18, s66, v17
    s_mul_i32 s67, s61, 4224
    v_lshl_add_u32 v120, v16, 7, v18
    v_add_u32 v120, s67, v120
    v_mul_u32_u24 v121, 4224, v16
    v_add_u32 v121, v121, v18
    v_lshl_add_u32 v121, s61, 7, v121
    v_and_b32 v18, 1, v12
    v_lshl_add_u32 v18, v18, 6, v17
    v_and_b32 v20, 3, v16
    v_lshl_add_u32 v18, v20, 14, v18
    s_lshl_b32 s66, s61, 16
    s_lshl_b32 s67, s60, 8
    s_add_u32 s66, s66, s67
    s_lshl_b32 s67, s68, 7
    s_add_u32 s66, s66, s67
    s_add_u32 s66, s66, 4194304
    v_add_u32 v122, s66, v18
    s_and_b32 s66, s61, 3
    s_lshl_b32 s66, s66, 2
    s_and_b32 s67, s61, 4
    s_lshl_b32 s67, s67, 3
    s_add_u32 s66, s66, s67
    s_mov_b64 s[90:91], 0xf000f
    s_lshl_b64 s[90:91], s[90:91], s66
    s_mov_b32 s92, 0xffffffff
    s_mov_b32 s93, 0xffff
    s_and_b32 s66, s61, 7
    s_lshl_b32 s66, s66, 7
    s_lshl_b32 s67, s62, 4
    s_add_u32 s66, s66, s67
    s_lshl_b32 s67, s68, 6
    s_add_u32 s66, s66, s67
    v_lshlrev_b32 v18, 3, v12
    v_lshl_add_u32 v18, v19, 10, v18
    v_add_u32 v123, s66, v18
    v_lshlrev_b32 v87, 3, v19
    v_add_u32 v87, 160080, v87
    v_mul_u32_u24 v17, 20480, v19
    s_mul_i32 s66, s63, 5120
    s_and_b32 s67, s61, 7
    s_mul_i32 s67, s67, 320
    s_add_u32 s66, s66, s67
    s_lshl_b32 s67, s62, 4
    s_add_u32 s66, s66, s67
    v_add_u32 v17, s66, v17
    v_lshl_add_u32 v82, v12, 6, v17
    v_mul_u32_u24 v18, 2560, v12
    v_add_u32 v83, v17, v18
    s_add_u32 m0, s46, 6144
    s_add_u32 s44, s44, 4096
    s_and_b32 s44, s44, 0x1ffff
    s_waitcnt vmcnt(5)
    buffer_load_dwordx4 v4, s[32:35], s44 offen nt lds
    s_add_u32 m0, s46, 7168
    s_add_u32 s44, s44, 4096
    s_and_b32 s44, s44, 0x1ffff
    s_waitcnt vmcnt(5)
    buffer_load_dwordx4 v5, s[32:35], s44 offen nt lds
    s_add_u32 m0, s46, 8192
    s_add_u32 s44, s44, 4096
    s_and_b32 s44, s44, 0x1ffff
    s_waitcnt vmcnt(5)
    buffer_load_dwordx4 v2, s[32:35], s44 offen nt lds
    s_add_u32 m0, s46, 9216
    s_add_u32 s44, s44, 4096
    s_and_b32 s44, s44, 0x1ffff
    s_waitcnt vmcnt(5)
    buffer_load_dwordx4 v3, s[32:35], s44 offen nt lds
    s_add_u32 m0, s46, 10240
    s_add_u32 s44, s44, 4096
    s_and_b32 s44, s44, 0x1ffff
    s_waitcnt vmcnt(5)
    buffer_load_dwordx4 v4, s[32:35], s44 offen nt lds
    s_add_u32 m0, s46, 11264
    s_add_u32 s44, s44, 4096
    s_and_b32 s44, s44, 0x1ffff
    s_waitcnt vmcnt(5)
    buffer_load_dwordx4 v5, s[32:35], s44 offen nt lds
    s_add_u32 m0, s46, 12288
    s_add_u32 s44, s44, 4096
    s_and_b32 s44, s44, 0x1ffff
    s_waitcnt vmcnt(5)
    buffer_load_dwordx4 v2, s[32:35], s44 offen nt lds
    s_add_u32 m0, s46, 13312
    s_add_u32 s44, s44, 4096
    s_and_b32 s44, s44, 0x1ffff
    s_waitcnt vmcnt(5)
    buffer_load_dwordx4 v3, s[32:35], s44 offen nt lds
    s_add_u32 m0, s46, 14336
    s_add_u32 s44, s44, 4096
    s_and_b32 s44, s44, 0x1ffff
    s_waitcnt vmcnt(5)
    buffer_load_dwordx4 v4, s[32:35], s44 offen nt lds
    s_add_u32 m0, s46, 15360
    s_add_u32 s44, s44, 4096
    s_and_b32 s44, s44, 0x1ffff
    s_waitcnt vmcnt(5)
    buffer_load_dwordx4 v5, s[32:35], s44 offen nt lds
    s_add_u32 m0, s46, 16384
    s_add_u32 s44, s44, 4096
    s_and_b32 s44, s44, 0x1ffff
    s_waitcnt vmcnt(5)
    buffer_load_dwordx4 v2, s[32:35], s44 offen nt lds
    s_add_u32 m0, s46, 17408
    s_add_u32 s44, s44, 4096
    s_and_b32 s44, s44, 0x1ffff
    s_waitcnt vmcnt(5)
    buffer_load_dwordx4 v3, s[32:35], s44 offen nt lds
    s_add_u32 m0, s46, 18432
    s_add_u32 s44, s44, 4096
    s_and_b32 s44, s44, 0x1ffff
    s_waitcnt vmcnt(5)
    buffer_load_dwordx4 v4, s[32:35], s44 offen nt lds
    s_add_u32 m0, s46, 19456
    s_add_u32 s44, s44, 4096
    s_and_b32 s44, s44, 0x1ffff
    s_waitcnt vmcnt(5)
    buffer_load_dwordx4 v5, s[32:35], s44 offen nt lds
    s_add_u32 m0, s46, 20480
    s_add_u32 s44, s44, 4096
    s_and_b32 s44, s44, 0x1ffff
    s_waitcnt vmcnt(5)
    buffer_load_dwordx4 v2, s[32:35], s44 offen nt lds
    s_add_u32 m0, s46, 21504
    s_add_u32 s44, s44, 4096
    s_and_b32 s44, s44, 0x1ffff
    s_waitcnt vmcnt(5)
    buffer_load_dwordx4 v3, s[32:35], s44 offen nt lds
    s_add_u32 m0, s46, 22528
    s_add_u32 s44, s44, 4096
    s_and_b32 s44, s44, 0x1ffff
    s_waitcnt vmcnt(5)
    buffer_load_dwordx4 v4, s[32:35], s44 offen nt lds
    s_add_u32 m0, s46, 23552
    s_add_u32 s44, s44, 4096
    s_and_b32 s44, s44, 0x1ffff
    s_waitcnt vmcnt(5)
    buffer_load_dwordx4 v5, s[32:35], s44 offen nt lds
    s_add_u32 m0, s46, 24576
    s_add_u32 s44, s44, 4096
    s_and_b32 s44, s44, 0x1ffff
    s_waitcnt vmcnt(5)
    buffer_load_dwordx4 v2, s[32:35], s44 offen nt lds
    s_add_u32 m0, s46, 25600
    s_add_u32 s44, s44, 4096
    s_and_b32 s44, s44, 0x1ffff
    s_waitcnt vmcnt(5)
    buffer_load_dwordx4 v3, s[32:35], s44 offen nt lds
    s_add_u32 m0, s46, 26624
    s_add_u32 s44, s44, 4096
    s_and_b32 s44, s44, 0x1ffff
    s_waitcnt vmcnt(5)
    buffer_load_dwordx4 v4, s[32:35], s44 offen nt lds
    s_add_u32 m0, s46, 27648
    s_add_u32 s44, s44, 4096
    s_and_b32 s44, s44, 0x1ffff
    s_waitcnt vmcnt(5)
    buffer_load_dwordx4 v5, s[32:35], s44 offen nt lds
    s_add_u32 m0, s46, 28672
    s_add_u32 s44, s44, 4096
    s_and_b32 s44, s44, 0x1ffff
    s_waitcnt vmcnt(5)
    buffer_load_dwordx4 v2, s[32:35], s44 offen nt lds
    s_add_u32 m0, s46, 29696
    s_add_u32 s44, s44, 4096
    s_and_b32 s44, s44, 0x1ffff
    s_waitcnt vmcnt(5)
    buffer_load_dwordx4 v3, s[32:35], s44 offen nt lds
    s_add_u32 m0, s46, 30720
    s_add_u32 s44, s44, 4096
    s_and_b32 s44, s44, 0x1ffff
    s_waitcnt vmcnt(5)
    buffer_load_dwordx4 v4, s[32:35], s44 offen nt lds
    s_add_u32 m0, s46, 31744
    s_add_u32 s44, s44, 4096
    s_and_b32 s44, s44, 0x1ffff
    s_waitcnt vmcnt(5)
    buffer_load_dwordx4 v5, s[32:35], s44 offen nt lds
    s_waitcnt vmcnt(24)
    ds_read_b128 v[128:131], v8 offset:0
    ds_read_b128 v[132:135], v9 offset:0
    ds_read_b128 v[136:139], v10 offset:0
    ds_read_b128 v[140:143], v11 offset:0
    ds_read_b128 v[144:147], v8 offset:4096
    ds_read_b128 v[148:151], v9 offset:4096
    ds_read_b128 v[152:155], v10 offset:4096
    ds_read_b128 v[156:159], v11 offset:4096
    s_waitcnt lgkmcnt(0)
    s_waitcnt vmcnt(5)
    s_add_u32 m0, s46, 0
    s_mov_b32 s44, s45
    buffer_load_dwordx4 v6, s[36:39], s44 offen nt lds
    s_add_u32 m0, s46, 1024
    s_add_u32 s44, s44, 4096
    s_and_b32 s44, s44, 0x1ffff
    buffer_load_dwordx4 v7, s[36:39], s44 offen nt lds
    s_add_u32 m0, s46, 2048
    s_add_u32 s44, s44, 4096
    s_and_b32 s44, s44, 0x1ffff
    buffer_load_dwordx4 v6, s[36:39], s44 offen nt lds
    s_add_u32 m0, s46, 3072
    s_add_u32 s44, s44, 4096
    s_and_b32 s44, s44, 0x1ffff
    buffer_load_dwordx4 v7, s[36:39], s44 offen nt lds
    s_waitcnt vmcnt(20)
    ds_read_b128 v[160:163], v8 offset:8192
    ds_read_b128 v[164:167], v9 offset:8192
    ds_read_b128 v[168:171], v10 offset:8192
    ds_read_b128 v[172:175], v11 offset:8192
    ds_read_b128 v[176:179], v8 offset:12288
    ds_read_b128 v[180:183], v9 offset:12288
    ds_read_b128 v[184:187], v10 offset:12288
    ds_read_b128 v[188:191], v11 offset:12288
    s_waitcnt lgkmcnt(0)
    s_waitcnt vmcnt(5)
    s_add_u32 m0, s46, 4096
    s_add_u32 s44, s44, 4096
    s_and_b32 s44, s44, 0x1ffff
    buffer_load_dwordx4 v6, s[36:39], s44 offen nt lds
    s_add_u32 m0, s46, 5120
    s_add_u32 s44, s44, 4096
    s_and_b32 s44, s44, 0x1ffff
    buffer_load_dwordx4 v7, s[36:39], s44 offen nt lds
    s_add_u32 m0, s46, 6144
    s_add_u32 s44, s44, 4096
    s_and_b32 s44, s44, 0x1ffff
    buffer_load_dwordx4 v6, s[36:39], s44 offen nt lds
    s_add_u32 m0, s46, 7168
    s_add_u32 s44, s44, 4096
    s_and_b32 s44, s44, 0x1ffff
    buffer_load_dwordx4 v7, s[36:39], s44 offen nt lds
    s_waitcnt vmcnt(16)
    ds_read_b128 v[192:195], v8 offset:16384
    ds_read_b128 v[196:199], v9 offset:16384
    ds_read_b128 v[200:203], v10 offset:16384
    ds_read_b128 v[204:207], v11 offset:16384
    ds_read_b128 v[208:211], v8 offset:20480
    ds_read_b128 v[212:215], v9 offset:20480
    ds_read_b128 v[216:219], v10 offset:20480
    ds_read_b128 v[220:223], v11 offset:20480
    s_waitcnt lgkmcnt(0)
    s_waitcnt vmcnt(5)
    s_add_u32 m0, s46, 8192
    s_add_u32 s44, s44, 4096
    s_and_b32 s44, s44, 0x1ffff
    buffer_load_dwordx4 v6, s[36:39], s44 offen nt lds
    s_add_u32 m0, s46, 9216
    s_add_u32 s44, s44, 4096
    s_and_b32 s44, s44, 0x1ffff
    buffer_load_dwordx4 v7, s[36:39], s44 offen nt lds
    s_add_u32 m0, s46, 10240
    s_add_u32 s44, s44, 4096
    s_and_b32 s44, s44, 0x1ffff
    buffer_load_dwordx4 v6, s[36:39], s44 offen nt lds
    s_add_u32 m0, s46, 11264
    s_add_u32 s44, s44, 4096
    s_and_b32 s44, s44, 0x1ffff
    buffer_load_dwordx4 v7, s[36:39], s44 offen nt lds
    s_waitcnt vmcnt(12)
    ds_read_b128 v[224:227], v8 offset:24576
    ds_read_b128 v[228:231], v9 offset:24576
    ds_read_b128 v[232:235], v10 offset:24576
    ds_read_b128 v[236:239], v11 offset:24576
    ds_read_b128 v[240:243], v8 offset:28672
    ds_read_b128 v[244:247], v9 offset:28672
    ds_read_b128 v[248:251], v10 offset:28672
    ds_read_b128 v[252:255], v11 offset:28672
    s_waitcnt lgkmcnt(0)
    s_waitcnt vmcnt(5)
    s_add_u32 m0, s46, 12288
    s_add_u32 s44, s44, 4096
    s_and_b32 s44, s44, 0x1ffff
    buffer_load_dwordx4 v6, s[36:39], s44 offen nt lds
    s_add_u32 m0, s46, 13312
    s_add_u32 s44, s44, 4096
    s_and_b32 s44, s44, 0x1ffff
    buffer_load_dwordx4 v7, s[36:39], s44 offen nt lds
    s_add_u32 m0, s46, 14336
    s_add_u32 s44, s44, 4096
    s_and_b32 s44, s44, 0x1ffff
    buffer_load_dwordx4 v6, s[36:39], s44 offen nt lds
    s_add_u32 m0, s46, 15360
    s_add_u32 s44, s44, 4096
    s_and_b32 s44, s44, 0x1ffff
    buffer_load_dwordx4 v7, s[36:39], s44 offen nt lds
    v_mov_b32 v10, 159948
    v_mov_b32 v11, 159936
    v_mov_b32 v8, 1
    s_mov_b32 s47, 0
    s_mul_i32 s95, s64, 0x9e3779b1
    s_add_u32 s95, s95, 0x7f4a7c15
    s_or_b32 s95, s95, 8
    s_bfe_u32 s66, s95, 0xc0008
    s_or_b32 s66, s66, 0x80
    v_mov_b32 v3, s66
    s_cmp_lg_u32 s47, 0
    s_cbranch_scc1 Lc_1
    ds_read_b32 v9, v11
    s_waitcnt lgkmcnt(0)
    v_cmp_ne_u32 vcc, s95, v9
    s_cbranch_vccnz Lc_2
    s_call_b64 s[48:49], L_sub_s
Lc_1:
Lc_2:
    s_waitcnt vmcnt(5)
    s_add_u32 m0, s46, 16384
    s_add_u32 s44, s44, 4096
    s_and_b32 s44, s44, 0x1ffff
    buffer_load_dwordx4 v6, s[36:39], s44 offen nt lds
    s_add_u32 m0, s46, 17408
    s_add_u32 s44, s44, 4096
    s_and_b32 s44, s44, 0x1ffff
    buffer_load_dwordx4 v7, s[36:39], s44 offen nt lds
    s_add_u32 m0, s46, 18432
    s_add_u32 s44, s44, 4096
    s_and_b32 s44, s44, 0x1ffff
    buffer_load_dwordx4 v6, s[36:39], s44 offen nt lds
    s_add_u32 m0, s46, 19456
    s_add_u32 s44, s44, 4096
    s_and_b32 s44, s44, 0x1ffff
    buffer_load_dwordx4 v7, s[36:39], s44 offen nt lds
    s_cmp_lg_u32 s47, 0
    s_cbranch_scc1 Lc_3
    ds_read_b32 v9, v11
    s_waitcnt lgkmcnt(0)
    v_cmp_ne_u32 vcc, s95, v9
    s_cbranch_vccnz Lc_4
    s_call_b64 s[48:49], L_sub_s
Lc_3:
Lc_4:
    s_waitcnt vmcnt(5)
    s_add_u32 m0, s46, 20480
    s_add_u32 s44, s44, 4096
    s_and_b32 s44, s44, 0x1ffff
    buffer_load_dwordx4 v6, s[36:39], s44 offen nt lds
    s_add_u32 m0, s46, 21504
    s_add_u32 s44, s44, 4096
    s_and_b32 s44, s44, 0x1ffff
    buffer_load_dwordx4 v7, s[36:39], s44 offen nt lds
    s_add_u32 m0, s46, 22528
    s_add_u32 s44, s44, 4096
    s_and_b32 s44, s44, 0x1ffff
    buffer_load_dwordx4 v6, s[36:39], s44 offen nt lds
    s_add_u32 m0, s46, 23552
    s_add_u32 s44, s44, 4096
    s_and_b32 s44, s44, 0x1ffff
    buffer_load_dwordx4 v7, s[36:39], s44 offen nt lds
    s_cmp_lg_u32 s47, 0
    s_cbranch_scc1 Lc_5
    ds_read_b32 v9, v11
    s_waitcnt lgkmcnt(0)
    v_cmp_ne_u32 vcc, s95, v9
    s_cbranch_vccnz Lc_6
    s_call_b64 s[48:49], L_sub_s
Lc_5:
    s_cmp_lg_u32 s47, 1
    s_cbranch_scc1 Lc_6
    s_waitcnt vmcnt(8)
    s_waitcnt lgkmcnt(0)
    s_mov_b64 exec, 1
    ds_add_u32 v10, v8 offset:0
    s_mov_b64 exec, -1
    s_mov_b32 s47, 2
Lc_6:
    s_waitcnt vmcnt(5)
    s_add_u32 m0, s46, 24576
    s_add_u32 s44, s44, 4096
    s_and_b32 s44, s44, 0x1ffff
    buffer_load_dwordx4 v6, s[36:39], s44 offen nt lds
    s_add_u32 m0, s46, 25600
    s_add_u32 s44, s44, 4096
    s_and_b32 s44, s44, 0x1ffff
    buffer_load_dwordx4 v7, s[36:39], s44 offen nt lds
    s_add_u32 m0, s46, 26624
    s_add_u32 s44, s44, 4096
    s_and_b32 s44, s44, 0x1ffff
    buffer_load_dwordx4 v6, s[36:39], s44 offen nt lds
    s_add_u32 m0, s46, 27648
    s_add_u32 s44, s44, 4096
    s_and_b32 s44, s44, 0x1ffff
    buffer_load_dwordx4 v7, s[36:39], s44 offen nt lds
    s_cmp_lg_u32 s47, 2
    s_cbranch_scc1 Lc_9
    ds_read_b32 v9, v10
    s_waitcnt lgkmcnt(0)
    v_cmp_gt_u32 vcc, 4, v9
    s_cbranch_vccnz Lc_8
    s_call_b64 s[48:49], L_sub_pv
    s_branch Lc_8
Lc_9:
    s_cmp_lg_u32 s47, 0
    s_cbranch_scc1 Lc_7
    ds_read_b32 v9, v11
    s_waitcnt lgkmcnt(0)
    v_cmp_ne_u32 vcc, s95, v9
    s_cbranch_vccnz Lc_8
    s_call_b64 s[48:49], L_sub_s
Lc_7:
    s_cmp_lg_u32 s47, 1
    s_cbranch_scc1 Lc_8
    s_waitcnt vmcnt(12)
    s_waitcnt lgkmcnt(0)
    s_mov_b64 exec, 1
    ds_add_u32 v10, v8 offset:0
    s_mov_b64 exec, -1
    s_mov_b32 s47, 2
Lc_8:
    s_waitcnt vmcnt(5)
    s_add_u32 m0, s46, 28672
    s_add_u32 s44, s44, 4096
    s_and_b32 s44, s44, 0x1ffff
    buffer_load_dwordx4 v6, s[36:39], s44 offen nt lds
    v_lshl_add_u32 v9, s63, 2, v11
    v_mov_b32 v14, s95
    ds_write_b32 v9, v14 offset:16
    s_add_u32 m0, s46, 29696
    s_add_u32 s44, s44, 4096
    s_and_b32 s44, s44, 0x1ffff
    buffer_load_dwordx4 v7, s[36:39], s44 offen nt lds
    s_add_u32 m0, s46, 30720
    s_add_u32 s44, s44, 4096
    s_and_b32 s44, s44, 0x1ffff
    buffer_load_dwordx4 v6, s[36:39], s44 offen nt lds
    s_add_u32 m0, s46, 31744
    s_add_u32 s44, s44, 4096
    s_and_b32 s44, s44, 0x1ffff
    buffer_load_dwordx4 v7, s[36:39], s44 offen nt lds
    s_cmp_lg_u32 s47, 0
    s_cbranch_scc1 Lc_10
    s_mov_b32 s70, 0
Lh_13:
    s_sleep 1
    ds_read_b32 v9, v11
    s_add_u32 s70, s70, 1
    s_cmp_gt_u32 s70, 0x4000
    s_cbranch_scc1 L_fail
    s_waitcnt lgkmcnt(0)
    v_cmp_ne_u32 vcc, s95, v9
    s_cbranch_vccnz Lh_13
    s_call_b64 s[48:49], L_sub_s
Lc_10:
    s_cmp_lg_u32 s47, 1
    s_cbranch_scc1 Lc_11
    s_waitcnt vmcnt(16)
    s_waitcnt lgkmcnt(0)
    s_mov_b64 exec, 1
    ds_add_u32 v10, v8 offset:0
    s_mov_b64 exec, -1
    s_mov_b32 s47, 2
Lc_11:
    s_cmp_lg_u32 s47, 2
    s_cbranch_scc1 Lc_12
    v_mov_b32 v10, 159948
    s_mov_b32 s70, 0
Lh_14:
    ds_read_b32 v9, v10
    s_add_u32 s70, s70, 1
    s_cmp_gt_u32 s70, 0x4000
    s_cbranch_scc1 L_fail
    s_waitcnt lgkmcnt(0)
    v_cmp_gt_u32 vcc, 4, v9
    s_cbranch_vccnz Lh_14
    s_call_b64 s[48:49], L_sub_pv
Lc_12:
    s_waitcnt vmcnt(8) lgkmcnt(0)
    s_mov_b64 exec, 1
    ds_add_u32 v10, v8 offset:0
    s_mov_b64 exec, -1
    s_mov_b32 s70, 0
Lh_15:
    ds_read_b32 v9, v10
    s_add_u32 s70, s70, 1
    s_cmp_gt_u32 s70, 0x8000
    s_cbranch_scc1 L_fail
    s_waitcnt lgkmcnt(0)
    v_cmp_gt_u32 vcc, 8, v9
    s_cbranch_vccnz Lh_15
    ds_read_b128 v[16:19], v117 offset:128
    ds_read_b64_tr_b16 v[20:21], v112 offset:16384
    ds_read_b64_tr_b16 v[22:23], v112 offset:20480
    ds_read_b64_tr_b16 v[24:25], v113 offset:16384
    ds_read_b64_tr_b16 v[26:27], v113 offset:20480
    ds_read_b128 v[64:67], v117 offset:1152
    ds_read_b64_tr_b16 v[68:69], v112 offset:49152
    ds_read_b64_tr_b16 v[70:71], v112 offset:53248
    ds_read_b64_tr_b16 v[72:73], v113 offset:49152
    ds_read_b64_tr_b16 v[74:75], v113 offset:53248
    ds_read_b128 v[100:103], v117 offset:2176
    ds_read_b64_tr_b16 v[104:105], v114 offset:16384
    ds_read_b64_tr_b16 v[106:107], v114 offset:20480
    ds_read_b64_tr_b16 v[108:109], v115 offset:16384
    ds_read_b64_tr_b16 v[110:111], v115 offset:20480
    s_waitcnt lgkmcnt(10)
    v_mfma_f32_16x16x32_bf16 v[32:35], v[20:23], v[16:19], v[32:35]
    v_mfma_f32_16x16x32_bf16 v[36:39], v[24:27], v[16:19], v[36:39]
    ds_read_b128 v[16:19], v117 offset:3200
    ds_read_b64_tr_b16 v[20:21], v114 offset:49152
    ds_read_b64_tr_b16 v[22:23], v114 offset:53248
    ds_read_b64_tr_b16 v[24:25], v115 offset:49152
    ds_read_b64_tr_b16 v[26:27], v115 offset:53248
    s_waitcnt lgkmcnt(10)
    v_mfma_f32_16x16x32_bf16 v[40:43], v[68:71], v[64:67], v[40:43]
    v_mfma_f32_16x16x32_bf16 v[44:47], v[72:75], v[64:67], v[44:47]
    s_waitcnt lgkmcnt(5)
    v_mfma_f32_16x16x32_bf16 v[48:51], v[104:107], v[100:103], v[48:51]
    v_mfma_f32_16x16x32_bf16 v[52:55], v[108:111], v[100:103], v[52:55]
    s_waitcnt lgkmcnt(0)
    v_mfma_f32_16x16x32_bf16 v[56:59], v[20:23], v[16:19], v[56:59]
    v_mfma_f32_16x16x32_bf16 v[60:63], v[24:27], v[16:19], v[60:63]
    ds_read_b128 v[16:19], v117 offset:192
    ds_read_b128 v[20:23], v117 offset:1216
    ds_read_b128 v[24:27], v117 offset:2240
    ds_read_b128 v[28:31], v117 offset:3264
    s_waitcnt vmcnt(0) lgkmcnt(0)
    s_mov_b64 exec, 1
    ds_add_u32 v10, v8 offset:0
    s_mov_b64 exec, -1
    s_mov_b32 s70, 0
Lh_16:
    ds_read_b32 v9, v10
    s_add_u32 s70, s70, 1
    s_cmp_gt_u32 s70, 0x8000
    s_cbranch_scc1 L_fail
    s_waitcnt lgkmcnt(0)
    v_cmp_gt_u32 vcc, 12, v9
    s_cbranch_vccnz Lh_16
    ds_read_b64_tr_b16 v[64:65], v112 offset:24576
    ds_read_b64_tr_b16 v[66:67], v112 offset:28672
    ds_read_b64_tr_b16 v[68:69], v113 offset:24576
    ds_read_b64_tr_b16 v[70:71], v113 offset:28672
    ds_read_b64_tr_b16 v[72:73], v112 offset:57344
    ds_read_b64_tr_b16 v[74:75], v112 offset:61440
    ds_read_b64_tr_b16 v[76:77], v113 offset:57344
    ds_read_b64_tr_b16 v[78:79], v113 offset:61440
    ds_read_b64_tr_b16 v[96:97], v114 offset:24576
    ds_read_b64_tr_b16 v[98:99], v114 offset:28672
    ds_read_b64_tr_b16 v[100:101], v115 offset:24576
    ds_read_b64_tr_b16 v[102:103], v115 offset:28672
    ds_read_b64_tr_b16 v[104:105], v114 offset:57344
    ds_read_b64_tr_b16 v[106:107], v114 offset:61440
    ds_read_b64_tr_b16 v[108:109], v115 offset:57344
    ds_read_b64_tr_b16 v[110:111], v115 offset:61440
    s_waitcnt lgkmcnt(12)
    v_mfma_f32_16x16x32_bf16 v[32:35], v[64:67], v[16:19], v[32:35]
    v_mfma_f32_16x16x32_bf16 v[36:39], v[68:71], v[16:19], v[36:39]
    s_waitcnt lgkmcnt(8)
    v_mfma_f32_16x16x32_bf16 v[40:43], v[72:75], v[20:23], v[40:43]
    v_mfma_f32_16x16x32_bf16 v[44:47], v[76:79], v[20:23], v[44:47]
    s_waitcnt lgkmcnt(4)
    v_mfma_f32_16x16x32_bf16 v[48:51], v[96:99], v[24:27], v[48:51]
    v_mfma_f32_16x16x32_bf16 v[52:55], v[100:103], v[24:27], v[52:55]
    s_nop 0
    v_pk_mul_f32 v[72:73], v[32:33], v[88:89] op_sel:[0,0] op_sel_hi:[1,0]
    v_pk_mul_f32 v[74:75], v[34:35], v[88:89] op_sel:[0,0] op_sel_hi:[1,0]
    v_pk_mul_f32 v[76:77], v[36:37], v[88:89] op_sel:[0,0] op_sel_hi:[1,0]
    v_pk_mul_f32 v[78:79], v[38:39], v[88:89] op_sel:[0,0] op_sel_hi:[1,0]
    s_waitcnt lgkmcnt(0)
    v_mfma_f32_16x16x32_bf16 v[56:59], v[104:107], v[28:31], v[56:59]
    v_mfma_f32_16x16x32_bf16 v[60:63], v[108:111], v[28:31], v[60:63]
    v_pk_fma_f32 v[72:73], v[40:41], v[88:89], v[72:73] op_sel:[0,1,0] op_sel_hi:[1,1,1]
    v_pk_fma_f32 v[74:75], v[42:43], v[88:89], v[74:75] op_sel:[0,1,0] op_sel_hi:[1,1,1]
    v_pk_fma_f32 v[76:77], v[44:45], v[88:89], v[76:77] op_sel:[0,1,0] op_sel_hi:[1,1,1]
    v_pk_fma_f32 v[78:79], v[46:47], v[88:89], v[78:79] op_sel:[0,1,0] op_sel_hi:[1,1,1]
    v_pk_fma_f32 v[72:73], v[48:49], v[90:91], v[72:73] op_sel:[0,0,0] op_sel_hi:[1,0,1]
    v_pk_fma_f32 v[74:75], v[50:51], v[90:91], v[74:75] op_sel:[0,0,0] op_sel_hi:[1,0,1]
    v_pk_fma_f32 v[76:77], v[52:53], v[90:91], v[76:77] op_sel:[0,0,0] op_sel_hi:[1,0,1]
    v_pk_fma_f32 v[78:79], v[54:55], v[90:91], v[78:79] op_sel:[0,0,0] op_sel_hi:[1,0,1]
    v_pk_fma_f32 v[72:73], v[56:57], v[90:91], v[72:73] op_sel:[0,1,0] op_sel_hi:[1,1,1]
    v_pk_fma_f32 v[74:75], v[58:59], v[90:91], v[74:75] op_sel:[0,1,0] op_sel_hi:[1,1,1]
    v_pk_fma_f32 v[76:77], v[60:61], v[90:91], v[76:77] op_sel:[0,1,0] op_sel_hi:[1,1,1]
    v_pk_fma_f32 v[78:79], v[62:63], v[90:91], v[78:79] op_sel:[0,1,0] op_sel_hi:[1,1,1]
    v_and_or_b32 v72, v72, s94, v3
    v_and_or_b32 v73, v73, s94, v3
    v_and_or_b32 v74, v74, s94, v3
    v_and_or_b32 v75, v75, s94, v3
    v_and_or_b32 v76, v76, s94, v3
    v_and_or_b32 v77, v77, s94, v3
    v_and_or_b32 v78, v78, s94, v3
    v_and_or_b32 v79, v79, s94, v3
    s_mov_b64 exec, s[88:89]
    s_cmp_eq_u32 s65, 0
    s_cbranch_scc1 Ls_17
    buffer_store_dwordx4 v[72:75], v82, s[28:31], s75 offen offset:0
    buffer_store_dwordx4 v[76:79], v82, s[28:31], s75 offen offset:2560
    s_mov_b32 exec_hi, 0
    buffer_store_dwordx4 v[124:127], v83, s[28:31], s75 offen offset:256
Lb_18:
    s_mov_b64 exec, -1
    s_barrier
    v_and_b32 v16, 1, v1
    v_lshlrev_b32 v16, 4, v16
    v_mov_b32 v17, 0x3f80
    v_lshlrev_b32 v16, v16, v17
    v_bfe_u32 v17, v1, 1, 2
    v_cmp_eq_u32 vcc, 0, v17
    s_nop 1
    v_cndmask_b32 v8, 0, v16, vcc
    v_cmp_eq_u32 vcc, 1, v17
    s_nop 1
    v_cndmask_b32 v9, 0, v16, vcc
    v_cmp_eq_u32 vcc, 2, v17
    s_nop 1
    v_cndmask_b32 v10, 0, v16, vcc
    v_cmp_eq_u32 vcc, 3, v17
    s_nop 1
    v_cndmask_b32 v11, 0, v16, vcc
    s_add_u32 s66, s64, 1
    s_and_b32 s66, s66, 0x7f
    v_mov_b32 v5, s66
    s_bfe_u32 s66, s64, 0x70007
    v_mov_b32 v118, s66
    v_mov_b32 v16, 160072
    ds_read_b32 v17, v16
    v_bfe_u32 v18, v1, 2, 2
    v_lshrrev_b32 v19, 5, v1
    v_lshl_add_u32 v19, v19, 2, v18
    s_mov_b32 s50, 0x1111
    s_mov_b32 s51, 0x1111
    s_waitcnt lgkmcnt(0)
    v_lshrrev_b32 v17, v19, v17
    v_and_b32 v17, 1, v17
    v_lshl_add_u32 v17, v17, 13, v122
    v_add_u32 v19, 0, v18
    v_and_b32 v19, 3, v19
    v_lshl_add_u32 v2, v19, 11, v17
    v_add_u32 v19, 1, v18
    v_and_b32 v19, 3, v19
    v_lshl_add_u32 v12, v19, 11, v17
    v_add_u32 v19, 2, v18
    v_and_b32 v19, 3, v19
    v_lshl_add_u32 v13, v19, 11, v17
    v_add_u32 v19, 3, v18
    v_and_b32 v19, 3, v19
    v_lshl_add_u32 v14, v19, 11, v17
    v_mov_b32 v3, 0x1
    s_barrier
    s_cmp_gt_u32 s63, 1
    s_cbranch_scc1 Lk_19
    s_mov_b32 s70, 0
    s_sleep 3
Lp_20:
    buffer_load_dwordx4 v[16:19], v121, s[28:31], s72 offen nt
    buffer_load_dwordx4 v[20:23], v121, s[28:31], s73 offen  nt
    s_add_u32 s70, s70, 1
    s_cmp_gt_u32 s70, 0x2000
    s_cbranch_scc1 L_fail
    s_waitcnt vmcnt(0)
    v_xor_b32 v4, v16, v3
    v_bitop3_b32 v4, v4, v20, v3 bitop3:0xf6
    v_and_b32 v4, 0x10001, v4
    v_cmp_ne_u32 vcc, 0, v4
    s_cbranch_vccnz Lp_20
    v_mfma_f32_16x16x32_bf16 v[24:27], v[8:11], v[16:19], 0
    v_mfma_f32_16x16x32_bf16 v[24:27], v[8:11], v[20:23], v[24:27]
    s_nop 7
    v_add_f32_dpp v24, v24, v24 row_ror:4 row_mask:0xf bank_mask:0xf
    v_add_f32_dpp v25, v25, v25 row_ror:4 row_mask:0xf bank_mask:0xf
    v_add_f32_dpp v26, v26, v26 row_ror:4 row_mask:0xf bank_mask:0xf
    v_add_f32_dpp v27, v27, v27 row_ror:4 row_mask:0xf bank_mask:0xf
    v_add_f32_dpp v24, v24, v24 row_ror:8 row_mask:0xf bank_mask:0xf
    v_add_f32_dpp v25, v25, v25 row_ror:8 row_mask:0xf bank_mask:0xf
    v_add_f32_dpp v26, v26, v26 row_ror:8 row_mask:0xf bank_mask:0xf
    v_add_f32_dpp v27, v27, v27 row_ror:8 row_mask:0xf bank_mask:0xf
    v_and_or_b32 v24, v24, s78, v5
    v_and_or_b32 v26, v26, s78, v118
    buffer_store_dwordx4 v[24:27], v2, s[28:31], 0 offen sc1
Lk_19:
    s_barrier
    s_cmp_lt_u32 s63, 2
    s_cbranch_scc1 Lk_21
    s_mov_b64 exec, s[50:51]
    buffer_load_dword v30, v12, s[28:31], 0 offen
    s_mov_b64 exec, -1
Lk_21:
    v_mov_b32 v3, 0x10001
    v_mov_b32 v20, v3
    v_mov_b32 v21, 0
    v_mov_b32 v22, 0
    v_mov_b32 v23, 0
    s_barrier
    ds_read_b64 v[6:7], v87
    s_cmp_gt_u32 s63, 1
    s_cbranch_scc1 Lk_22
    s_mov_b32 s70, 0
    s_sleep 3
Lp_23:
    buffer_load_dwordx4 v[16:19], v121, s[28:31], s72 offen nt
    s_mov_b64 exec, s[92:93]
    buffer_load_dwordx4 v[20:23], v121, s[28:31], s73 offen  nt
    s_mov_b64 exec, -1
    s_add_u32 s70, s70, 1
    s_cmp_gt_u32 s70, 0x2000
    s_cbranch_scc1 L_fail
    s_waitcnt vmcnt(0)
    v_xor_b32 v4, v16, v3
    v_bitop3_b32 v4, v4, v20, v3 bitop3:0xf6
    v_and_b32 v4, 0x10001, v4
    v_cmp_ne_u32 vcc, 0, v4
    s_cbranch_vccnz Lp_23
    v_mfma_f32_16x16x32_bf16 v[24:27], v[8:11], v[16:19], 0
    v_mfma_f32_16x16x32_bf16 v[24:27], v[8:11], v[20:23], v[24:27]
    s_nop 7
    v_add_f32_dpp v24, v24, v24 row_ror:4 row_mask:0xf bank_mask:0xf
    v_add_f32_dpp v25, v25, v25 row_ror:4 row_mask:0xf bank_mask:0xf
    v_add_f32_dpp v26, v26, v26 row_ror:4 row_mask:0xf bank_mask:0xf
    v_add_f32_dpp v27, v27, v27 row_ror:4 row_mask:0xf bank_mask:0xf
    v_add_f32_dpp v24, v24, v24 row_ror:8 row_mask:0xf bank_mask:0xf
    v_add_f32_dpp v25, v25, v25 row_ror:8 row_mask:0xf bank_mask:0xf
    v_add_f32_dpp v26, v26, v26 row_ror:8 row_mask:0xf bank_mask:0xf
    v_add_f32_dpp v27, v27, v27 row_ror:8 row_mask:0xf bank_mask:0xf
    s_waitcnt lgkmcnt(0)
    v_pk_mul_f32 v[24:25], v[24:25], v[6:7] op_sel_hi:[1,0]
    v_pk_mul_f32 v[26:27], v[26:27], v[6:7] op_sel_hi:[1,0]
    v_and_or_b32 v24, v24, s78, v5
    v_and_or_b32 v26, v26, s78, v118
    buffer_store_dwordx4 v[24:27], v12, s[28:31], 0 offen sc1
Lk_22:
    s_barrier
    v_mov_b32 v3, 0x0
    s_lshl_b32 s68, s62, 10
    s_add_u32 s68, s68, s76
    s_barrier
    s_cmp_gt_u32 s63, 1
    s_cbranch_scc0 Lk_24
    s_sleep 11
Lk_24:
    s_cmp_gt_u32 s63, 1
    s_cbranch_scc1 Lk_25
    s_mov_b32 s70, 0
    s_sleep 3
Lp_26:
    buffer_load_dwordx4 v[16:19], v120, s[28:31], s72 offen nt
    buffer_load_dwordx4 v[20:23], v120, s[28:31], s72 offen offset:2048 nt
    s_add_u32 s70, s70, 1
    s_cmp_gt_u32 s70, 0x2000
    s_cbranch_scc1 L_fail
    s_waitcnt vmcnt(0)
    v_xor_b32 v4, v16, v3
    v_bitop3_b32 v4, v4, v20, v3 bitop3:0xf6
    v_and_b32 v4, 0x10001, v4
    v_cmp_ne_u32 vcc, 0, v4
    s_cbranch_vccnz Lp_26
    v_mfma_f32_16x16x32_bf16 v[24:27], v[8:11], v[16:19], 0
    v_mfma_f32_16x16x32_bf16 v[24:27], v[8:11], v[20:23], v[24:27]
    s_nop 7
    v_add_f32_dpp v24, v24, v24 row_ror:4 row_mask:0xf bank_mask:0xf
    v_add_f32_dpp v25, v25, v25 row_ror:4 row_mask:0xf bank_mask:0xf
    v_add_f32_dpp v26, v26, v26 row_ror:4 row_mask:0xf bank_mask:0xf
    v_add_f32_dpp v27, v27, v27 row_ror:4 row_mask:0xf bank_mask:0xf
    v_add_f32_dpp v24, v24, v24 row_ror:8 row_mask:0xf bank_mask:0xf
    v_add_f32_dpp v25, v25, v25 row_ror:8 row_mask:0xf bank_mask:0xf
    v_add_f32_dpp v26, v26, v26 row_ror:8 row_mask:0xf bank_mask:0xf
    v_add_f32_dpp v27, v27, v27 row_ror:8 row_mask:0xf bank_mask:0xf
    v_cvt_pk_bf16_f32 v24, v24, v25
    v_cvt_pk_bf16_f32 v25, v26, v27
    v_min_u32 v24, -2, v24
    v_min_u32 v25, -2, v25
    s_mov_b64 exec, 0xf000f
    s_cmp_eq_u32 s65, 0
    s_cbranch_scc1 Ls_27
    buffer_store_dwordx2 v[24:25], v123, s[28:31], s76 offen
Lb_28:
Lk_25:
    s_mov_b64 exec, -1
    s_add_u32 s66, s64, 2
    s_and_b32 s66, s66, 0x7f
    v_mov_b32 v3, s66
    s_mov_b64 exec, s[88:89]
    s_mov_b32 s70, 0
    s_sleep 5
Lp_29:
    buffer_load_dwordx4 v[16:19], v119, s[28:31], s68 offen offset:0 nt
    buffer_load_dwordx4 v[20:23], v119, s[28:31], s68 offen offset:256 nt
    buffer_load_dwordx4 v[24:27], v119, s[28:31], s68 offen offset:512 nt
    buffer_load_dwordx4 v[28:31], v119, s[28:31], s68 offen offset:768 nt
    s_add_u32 s70, s70, 1
    s_cmp_gt_u32 s70, 0x2000
    s_cbranch_scc1 L_fail
    s_waitcnt vmcnt(0)
    v_max3_u32 v4, v16, v17, v18
    v_max3_u32 v4, v4, v19, v20
    v_max3_u32 v4, v4, v21, v22
    v_max3_u32 v4, v4, v23, v24
    v_max3_u32 v4, v4, v25, v26
    v_max3_u32 v4, v4, v27, v28
    v_max3_u32 v4, v4, v29, v30
    v_max_u32 v4, v4, v31
    v_cmp_eq_u32 vcc, -1, v4
    s_cbranch_vccnz Lp_29
    s_mov_b64 exec, -1
    v_mfma_f32_16x16x32_bf16 v[32:35], v[128:131], v[16:19], 0
    v_mov_b32 v65, 160064
    ds_read_b32 v66, v65
    v_mfma_f32_16x16x32_bf16 v[32:35], v[132:135], v[20:23], v[32:35]
    v_and_b32 v81, 3, v1
    v_lshlrev_b32 v81, 4, v81
    v_mfma_f32_16x16x32_bf16 v[32:35], v[136:139], v[24:27], v[32:35]
    v_add_u32 v81, 160192, v81
    v_lshl_add_u32 v70, s63, 2, v81
    v_mfma_f32_16x16x32_bf16 v[32:35], v[140:143], v[28:31], v[32:35]
    v_mfma_f32_16x16x32_bf16 v[40:43], v[160:163], v[16:19], 0
    ds_read_b64_tr_b16 v[128:129], v112 offset:0
    ds_read_b64_tr_b16 v[130:131], v112 offset:4096
    v_mfma_f32_16x16x32_bf16 v[40:43], v[164:167], v[20:23], v[40:43]
    ds_read_b64_tr_b16 v[132:133], v113 offset:0
    ds_read_b64_tr_b16 v[134:135], v113 offset:4096
    v_mfma_f32_16x16x32_bf16 v[40:43], v[168:171], v[24:27], v[40:43]
    ds_read_b64_tr_b16 v[136:137], v112 offset:8192
    ds_read_b64_tr_b16 v[138:139], v112 offset:12288
    v_mfma_f32_16x16x32_bf16 v[40:43], v[172:175], v[28:31], v[40:43]
    ds_read_b64_tr_b16 v[140:141], v113 offset:8192
    ds_read_b64_tr_b16 v[142:143], v113 offset:12288
    s_waitcnt lgkmcnt(8)
    v_readfirstlane_b32 s71, v66
    v_mfma_f32_16x16x32_bf16 v[48:51], v[192:195], v[16:19], 0
    ds_read_b64_tr_b16 v[160:161], v112 offset:16384
    ds_read_b64_tr_b16 v[162:163], v112 offset:20480
    v_mfma_f32_16x16x32_bf16 v[48:51], v[196:199], v[20:23], v[48:51]
    ds_read_b64_tr_b16 v[164:165], v113 offset:16384
    ds_read_b64_tr_b16 v[166:167], v113 offset:20480
    v_mfma_f32_16x16x32_bf16 v[48:51], v[200:203], v[24:27], v[48:51]
    ds_read_b64_tr_b16 v[168:169], v112 offset:24576
    ds_read_b64_tr_b16 v[170:171], v112 offset:28672
    v_mfma_f32_16x16x32_bf16 v[48:51], v[204:207], v[28:31], v[48:51]
    ds_read_b64_tr_b16 v[172:173], v113 offset:24576
    ds_read_b64_tr_b16 v[174:175], v113 offset:28672
    v_mfma_f32_16x16x32_bf16 v[56:59], v[224:227], v[16:19], 0
    ds_read_b64_tr_b16 v[192:193], v112 offset:32768
    ds_read_b64_tr_b16 v[194:195], v112 offset:36864
    v_mfma_f32_16x16x32_bf16 v[56:59], v[228:231], v[20:23], v[56:59]
    ds_read_b64_tr_b16 v[196:197], v113 offset:32768
    ds_read_b64_tr_b16 v[198:199], v113 offset:36864
    v_mfma_f32_16x16x32_bf16 v[56:59], v[232:235], v[24:27], v[56:59]
    ds_read_b64_tr_b16 v[200:201], v112 offset:40960
    ds_read_b64_tr_b16 v[202:203], v112 offset:45056
    v_mfma_f32_16x16x32_bf16 v[56:59], v[236:239], v[28:31], v[56:59]
    ds_read_b64_tr_b16 v[204:205], v113 offset:40960
    ds_read_b64_tr_b16 v[206:207], v113 offset:45056
    v_mfma_f32_16x16x32_bf16 v[36:39], v[144:147], v[16:19], 0
    ds_read_b64_tr_b16 v[224:225], v112 offset:49152
    ds_read_b64_tr_b16 v[226:227], v112 offset:53248
    v_mfma_f32_16x16x32_bf16 v[36:39], v[148:151], v[20:23], v[36:39]
    ds_read_b64_tr_b16 v[228:229], v113 offset:49152
    ds_read_b64_tr_b16 v[230:231], v113 offset:53248
    v_mfma_f32_16x16x32_bf16 v[36:39], v[152:155], v[24:27], v[36:39]
    ds_read_b64_tr_b16 v[232:233], v112 offset:57344
    ds_read_b64_tr_b16 v[234:235], v112 offset:61440
    v_mfma_f32_16x16x32_bf16 v[36:39], v[156:159], v[28:31], v[36:39]
    ds_read_b64_tr_b16 v[236:237], v113 offset:57344
    ds_read_b64_tr_b16 v[238:239], v113 offset:61440
    v_mfma_f32_16x16x32_bf16 v[44:47], v[176:179], v[16:19], 0
    ds_read_b64_tr_b16 v[144:145], v114 offset:0
    v_mov_b32_dpp v32, v40 row_shr:4 row_mask:0xf bank_mask:0x2
    v_mfma_f32_16x16x32_bf16 v[44:47], v[180:183], v[20:23], v[44:47]
    ds_read_b64_tr_b16 v[146:147], v114 offset:4096
    v_mov_b32_dpp v33, v41 row_shr:4 row_mask:0xf bank_mask:0x2
    v_mfma_f32_16x16x32_bf16 v[44:47], v[184:187], v[24:27], v[44:47]
    ds_read_b64_tr_b16 v[148:149], v115 offset:0
    v_mov_b32_dpp v34, v42 row_shr:4 row_mask:0xf bank_mask:0x2
    v_mfma_f32_16x16x32_bf16 v[44:47], v[188:191], v[28:31], v[44:47]
    ds_read_b64_tr_b16 v[150:151], v115 offset:4096
    v_mov_b32_dpp v35, v43 row_shr:4 row_mask:0xf bank_mask:0x2
    v_mfma_f32_16x16x32_bf16 v[52:55], v[208:211], v[16:19], 0
    ds_read_b64_tr_b16 v[152:153], v114 offset:8192
    v_mov_b32_dpp v32, v48 row_shr:8 row_mask:0xf bank_mask:0x4
    v_mfma_f32_16x16x32_bf16 v[52:55], v[212:215], v[20:23], v[52:55]
    ds_read_b64_tr_b16 v[154:155], v114 offset:12288
    v_mov_b32_dpp v33, v49 row_shr:8 row_mask:0xf bank_mask:0x4
    v_mfma_f32_16x16x32_bf16 v[52:55], v[216:219], v[24:27], v[52:55]
    ds_read_b64_tr_b16 v[156:157], v115 offset:8192
    v_mov_b32_dpp v34, v50 row_shr:8 row_mask:0xf bank_mask:0x4
    v_mfma_f32_16x16x32_bf16 v[52:55], v[220:223], v[28:31], v[52:55]
    ds_read_b64_tr_b16 v[158:159], v115 offset:12288
    v_mov_b32_dpp v35, v51 row_shr:8 row_mask:0xf bank_mask:0x4
    v_mfma_f32_16x16x32_bf16 v[60:63], v[240:243], v[16:19], 0
    v_mov_b32_dpp v32, v56 row_shr:12 row_mask:0xf bank_mask:0x8
    v_mov_b32_dpp v33, v57 row_shr:12 row_mask:0xf bank_mask:0x8
    v_mfma_f32_16x16x32_bf16 v[60:63], v[244:247], v[20:23], v[60:63]
    v_mov_b32_dpp v34, v58 row_shr:12 row_mask:0xf bank_mask:0x8
    v_mov_b32_dpp v35, v59 row_shr:12 row_mask:0xf bank_mask:0x8
    v_mfma_f32_16x16x32_bf16 v[60:63], v[248:251], v[24:27], v[60:63]
    v_max3_f32 v80, v32, v33, v34
    v_max_f32 v80, v80, v35
    v_mfma_f32_16x16x32_bf16 v[60:63], v[252:255], v[28:31], v[60:63]
    v_mov_b32_dpp v36, v44 row_shr:4 row_mask:0xf bank_mask:0x2
    v_mov_b32_dpp v37, v45 row_shr:4 row_mask:0xf bank_mask:0x2
    v_mov_b32_dpp v38, v46 row_shr:4 row_mask:0xf bank_mask:0x2
    v_mov_b32_dpp v39, v47 row_shr:4 row_mask:0xf bank_mask:0x2
    v_mov_b32_dpp v36, v52 row_shr:8 row_mask:0xf bank_mask:0x4
    v_mov_b32_dpp v37, v53 row_shr:8 row_mask:0xf bank_mask:0x4
    v_mov_b32_dpp v38, v54 row_shr:8 row_mask:0xf bank_mask:0x4
    v_mov_b32_dpp v39, v55 row_shr:8 row_mask:0xf bank_mask:0x4
    s_cmp_gt_u32 s63, 1
    s_cbranch_scc1 Lk_30
    s_mov_b64 exec, s[50:51]
    buffer_load_dword v100, v13, s[28:31], 0 offen
    s_and_b64 exec, exec, s[90:91]
    buffer_load_dword v101, v14, s[28:31], 0 offen
    s_mov_b64 exec, -1
Lk_30:
    v_mov_b32_dpp v36, v60 row_shr:12 row_mask:0xf bank_mask:0x8
    v_mov_b32_dpp v37, v61 row_shr:12 row_mask:0xf bank_mask:0x8
    v_mov_b32_dpp v38, v62 row_shr:12 row_mask:0xf bank_mask:0x8
    v_mov_b32_dpp v39, v63 row_shr:12 row_mask:0xf bank_mask:0x8
    v_max3_f32 v80, v80, v36, v37
    v_max3_f32 v80, v80, v38, v39
    s_nop 1
    v_max_f32_dpp v80, v80, v80 row_ror:4 row_mask:0xf bank_mask:0xf
    s_nop 1
    v_max_f32_dpp v80, v80, v80 row_ror:8 row_mask:0xf bank_mask:0xf
    v_mov_b32 v64, v80
    s_nop 1
    v_permlane16_swap_b32 v80, v64
    v_max_f32 v80, v80, v64
    v_mov_b32 v64, v80
    s_nop 1
    v_permlane32_swap_b32 v80, v64
    v_max_f32 v80, v80, v64
    ds_write_b32 v70, v80
    s_cmp_eq_u32 s71, -1
    s_cbranch_scc1 Ls_31
Lb_32:
    v_mul_f32_e64 v64, s71, -v80
    v_fma_f32 v32, v32, s71, v64
    v_fma_f32 v33, v33, s71, v64
    v_fma_f32 v34, v34, s71, v64
    v_fma_f32 v35, v35, s71, v64
    v_fma_f32 v36, v36, s71, v64
    v_fma_f32 v37, v37, s71, v64
    v_fma_f32 v38, v38, s71, v64
    v_fma_f32 v39, v39, s71, v64
    v_exp_f32 v32, v32
    v_exp_f32 v33, v33
    v_exp_f32 v34, v34
    v_exp_f32 v35, v35
    v_exp_f32 v36, v36
    v_exp_f32 v37, v37
    v_exp_f32 v38, v38
    v_exp_f32 v39, v39
    v_cvt_pk_bf16_f32 v72, v32, v33
    v_cvt_pk_bf16_f32 v73, v34, v35
    v_cvt_pk_bf16_f32 v74, v36, v37
    v_cvt_pk_bf16_f32 v75, v38, v39
    ds_write_b128 v116, v[72:75]
    ds_read_b64_tr_b16 v[176:177], v114 offset:16384
    ds_read_b64_tr_b16 v[178:179], v114 offset:20480
    ds_read_b64_tr_b16 v[180:181], v115 offset:16384
    ds_read_b64_tr_b16 v[182:183], v115 offset:20480
    ds_read_b64_tr_b16 v[184:185], v114 offset:24576
    ds_read_b64_tr_b16 v[186:187], v114 offset:28672
    ds_read_b64_tr_b16 v[188:189], v115 offset:24576
    ds_read_b64_tr_b16 v[190:191], v115 offset:28672
    ds_read_b64_tr_b16 v[208:209], v114 offset:32768
    ds_read_b64_tr_b16 v[210:211], v114 offset:36864
    ds_read_b64_tr_b16 v[212:213], v115 offset:32768
    ds_read_b64_tr_b16 v[214:215], v115 offset:36864
    s_waitcnt lgkmcnt(12)
    s_barrier
    ds_read_b128 v[16:19], v117 offset:0
    ds_read_b128 v[20:23], v117 offset:64
    ds_read_b128 v[24:27], v117 offset:128
    ds_read_b128 v[28:31], v117 offset:192
    ds_read_b128 v[88:91], v81
    s_waitcnt lgkmcnt(1)
    v_mfma_f32_16x16x32_bf16 v[32:35], v[128:131], v[16:19], 0
    ds_read_b128 v[64:67], v117 offset:1024
    ds_read_b128 v[68:71], v117 offset:1088
    v_mfma_f32_16x16x32_bf16 v[36:39], v[132:135], v[16:19], 0
    ds_read_b128 v[72:75], v117 offset:1152
    ds_read_b128 v[76:79], v117 offset:1216
    v_mfma_f32_16x16x32_bf16 v[32:35], v[136:139], v[20:23], v[32:35]
    ds_read_b64_tr_b16 v[216:217], v114 offset:40960
    ds_read_b64_tr_b16 v[218:219], v114 offset:45056
    v_mfma_f32_16x16x32_bf16 v[36:39], v[140:143], v[20:23], v[36:39]
    ds_read_b64_tr_b16 v[220:221], v115 offset:40960
    ds_read_b64_tr_b16 v[222:223], v115 offset:45056
    v_mfma_f32_16x16x32_bf16 v[32:35], v[160:163], v[24:27], v[32:35]
    ds_read_b64_tr_b16 v[240:241], v114 offset:49152
    ds_read_b64_tr_b16 v[242:243], v114 offset:53248
    v_mfma_f32_16x16x32_bf16 v[36:39], v[164:167], v[24:27], v[36:39]
    ds_read_b64_tr_b16 v[244:245], v115 offset:49152
    ds_read_b64_tr_b16 v[246:247], v115 offset:53248
    v_mfma_f32_16x16x32_bf16 v[32:35], v[168:171], v[28:31], v[32:35]
    ds_read_b64_tr_b16 v[248:249], v114 offset:57344
    ds_read_b64_tr_b16 v[250:251], v114 offset:61440
    v_mfma_f32_16x16x32_bf16 v[36:39], v[172:175], v[28:31], v[36:39]
    ds_read_b64_tr_b16 v[252:253], v115 offset:57344
    ds_read_b64_tr_b16 v[254:255], v115 offset:61440
    s_waitcnt lgkmcnt(12)
    v_mfma_f32_16x16x32_bf16 v[40:43], v[192:195], v[64:67], 0
    ds_read_b128 v[16:19], v117 offset:2048
    ds_read_b128 v[20:23], v117 offset:2112
    v_mfma_f32_16x16x32_bf16 v[44:47], v[196:199], v[64:67], 0
    ds_read_b128 v[24:27], v117 offset:2176
    ds_read_b128 v[28:31], v117 offset:2240
    v_mfma_f32_16x16x32_bf16 v[40:43], v[200:203], v[68:71], v[40:43]
    v_max3_f32 v80, v88, v89, v90
    v_max_f32 v80, v80, v91
    v_mfma_f32_16x16x32_bf16 v[44:47], v[204:207], v[68:71], v[44:47]
    v_mul_f32_e64 v80, s71, -v80
    v_fma_f32 v88, v88, s71, v80
    v_mfma_f32_16x16x32_bf16 v[40:43], v[224:227], v[72:75], v[40:43]
    v_fma_f32 v89, v89, s71, v80
    v_fma_f32 v90, v90, s71, v80
    v_mfma_f32_16x16x32_bf16 v[44:47], v[228:231], v[72:75], v[44:47]
    v_fma_f32 v91, v91, s71, v80
    v_exp_f32 v88, v88
    v_mfma_f32_16x16x32_bf16 v[40:43], v[232:235], v[76:79], v[40:43]
    v_exp_f32 v89, v89
    v_exp_f32 v90, v90
    v_mfma_f32_16x16x32_bf16 v[44:47], v[236:239], v[76:79], v[44:47]
    v_exp_f32 v91, v91
    s_waitcnt lgkmcnt(0)
    v_mfma_f32_16x16x32_bf16 v[48:51], v[144:147], v[16:19], 0
    ds_read_b128 v[64:67], v117 offset:3072
    ds_read_b128 v[68:71], v117 offset:3136
    v_mfma_f32_16x16x32_bf16 v[52:55], v[148:151], v[16:19], 0
    ds_read_b128 v[72:75], v117 offset:3200
    ds_read_b128 v[76:79], v117 offset:3264
    v_mfma_f32_16x16x32_bf16 v[48:51], v[152:155], v[20:23], v[48:51]
    v_mul_f32 v104, v88, v32
    v_mul_f32 v105, v88, v33
    v_mfma_f32_16x16x32_bf16 v[52:55], v[156:159], v[20:23], v[52:55]
    v_mul_f32 v106, v88, v34
    v_mul_f32 v107, v88, v35
    v_mfma_f32_16x16x32_bf16 v[48:51], v[176:179], v[24:27], v[48:51]
    v_mul_f32 v108, v88, v36
    v_mul_f32 v109, v88, v37
    v_mfma_f32_16x16x32_bf16 v[52:55], v[180:183], v[24:27], v[52:55]
    v_mul_f32 v110, v88, v38
    v_mul_f32 v111, v88, v39
    v_mfma_f32_16x16x32_bf16 v[48:51], v[184:187], v[28:31], v[48:51]
    v_fmac_f32 v104, v89, v40
    v_fmac_f32 v105, v89, v41
    v_mfma_f32_16x16x32_bf16 v[52:55], v[188:191], v[28:31], v[52:55]
    v_fmac_f32 v106, v89, v42
    v_fmac_f32 v107, v89, v43
    s_waitcnt lgkmcnt(0)
    v_mfma_f32_16x16x32_bf16 v[56:59], v[208:211], v[64:67], 0
    v_fmac_f32 v108, v89, v44
    v_fmac_f32 v109, v89, v45
    v_mfma_f32_16x16x32_bf16 v[60:63], v[212:215], v[64:67], 0
    v_fmac_f32 v110, v89, v46
    v_fmac_f32 v111, v89, v47
    v_mfma_f32_16x16x32_bf16 v[56:59], v[216:219], v[68:71], v[56:59]
    v_fmac_f32 v104, v90, v48
    v_fmac_f32 v105, v90, v49
    v_mfma_f32_16x16x32_bf16 v[60:63], v[220:223], v[68:71], v[60:63]
    v_fmac_f32 v106, v90, v50
    v_fmac_f32 v107, v90, v51
    v_mfma_f32_16x16x32_bf16 v[56:59], v[240:243], v[72:75], v[56:59]
    v_fmac_f32 v108, v90, v52
    v_fmac_f32 v109, v90, v53
    v_mfma_f32_16x16x32_bf16 v[60:63], v[244:247], v[72:75], v[60:63]
    v_fmac_f32 v110, v90, v54
    v_fmac_f32 v111, v90, v55
    v_mfma_f32_16x16x32_bf16 v[56:59], v[248:251], v[76:79], v[56:59]
    v_mfma_f32_16x16x32_bf16 v[60:63], v[252:255], v[76:79], v[60:63]
    s_mov_b64 exec, s[88:89]
    s_nop 5
    v_pk_fma_f32 v[104:105], v[56:57], v[90:91], v[104:105] op_sel:[0,1,0] op_sel_hi:[1,1,1]
    v_pk_fma_f32 v[106:107], v[58:59], v[90:91], v[106:107] op_sel:[0,1,0] op_sel_hi:[1,1,1]
    v_pk_fma_f32 v[108:109], v[60:61], v[90:91], v[108:109] op_sel:[0,1,0] op_sel_hi:[1,1,1]
    v_pk_fma_f32 v[110:111], v[62:63], v[90:91], v[110:111] op_sel:[0,1,0] op_sel_hi:[1,1,1]
    v_and_or_b32 v104, v104, s78, v3
    v_and_or_b32 v108, v108, s78, v3
    s_cmp_eq_u32 s65, 0
    s_cbranch_scc1 Ls_34
    buffer_store_dwordx4 v[104:107], v82, s[28:31], s75 offen offset:0
    buffer_store_dwordx4 v[108:111], v82, s[28:31], s75 offen offset:2560
Lb_35:
    s_mov_b64 exec, -1
    s_barrier
    v_mov_b32 v3, 0x1
    s_barrier
    s_cmp_gt_u32 s63, 1
    s_cbranch_scc1 Lk_36
    s_mov_b32 s70, 0
    s_sleep 3
    s_nop 7
Lp_37:
    buffer_load_dwordx4 v[16:19], v121, s[28:31], s72 offen nt
    buffer_load_dwordx4 v[20:23], v121, s[28:31], s73 offen  nt
    s_add_u32 s70, s70, 1
    s_cmp_gt_u32 s70, 0x2000
    s_cbranch_scc1 L_fail
    s_waitcnt vmcnt(0)
    v_xor_b32 v4, v16, v3
    v_bitop3_b32 v4, v4, v20, v3 bitop3:0xf6
    v_and_b32 v4, 0x10001, v4
    v_cmp_ne_u32 vcc, 0, v4
    s_cbranch_vccnz Lp_37
    v_mfma_f32_16x16x32_bf16 v[24:27], v[8:11], v[16:19], 0
    v_mfma_f32_16x16x32_bf16 v[24:27], v[8:11], v[20:23], v[24:27]
    s_nop 7
    v_add_f32_dpp v24, v24, v24 row_ror:4 row_mask:0xf bank_mask:0xf
    v_add_f32_dpp v25, v25, v25 row_ror:4 row_mask:0xf bank_mask:0xf
    v_add_f32_dpp v26, v26, v26 row_ror:4 row_mask:0xf bank_mask:0xf
    v_add_f32_dpp v27, v27, v27 row_ror:4 row_mask:0xf bank_mask:0xf
    v_add_f32_dpp v24, v24, v24 row_ror:8 row_mask:0xf bank_mask:0xf
    v_add_f32_dpp v25, v25, v25 row_ror:8 row_mask:0xf bank_mask:0xf
    v_add_f32_dpp v26, v26, v26 row_ror:8 row_mask:0xf bank_mask:0xf
    v_add_f32_dpp v27, v27, v27 row_ror:8 row_mask:0xf bank_mask:0xf
    v_and_or_b32 v24, v24, s78, v5
    v_and_or_b32 v26, v26, s78, v118
    buffer_store_dwordx4 v[24:27], v13, s[28:31], 0 offen sc1
Lk_36:
    s_barrier
    v_mov_b32 v3, 0x10001
    v_mov_b32 v20, v3
    v_mov_b32 v21, 0
    v_mov_b32 v22, 0
    v_mov_b32 v23, 0
    s_barrier
    ds_read_b64 v[6:7], v87
    s_cmp_gt_u32 s63, 1
    s_cbranch_scc1 Lk_38
    s_mov_b32 s70, 0
    s_sleep 3
Lp_39:
    buffer_load_dwordx4 v[16:19], v121, s[28:31], s72 offen nt
    s_mov_b64 exec, s[92:93]
    buffer_load_dwordx4 v[20:23], v121, s[28:31], s73 offen  nt
    s_mov_b64 exec, -1
    s_add_u32 s70, s70, 1
    s_cmp_gt_u32 s70, 0x2000
    s_cbranch_scc1 L_fail
    s_waitcnt vmcnt(0)
    v_xor_b32 v4, v16, v3
    v_bitop3_b32 v4, v4, v20, v3 bitop3:0xf6
    v_and_b32 v4, 0x10001, v4
    v_cmp_ne_u32 vcc, 0, v4
    s_cbranch_vccnz Lp_39
    v_mfma_f32_16x16x32_bf16 v[24:27], v[8:11], v[16:19], 0
    v_mfma_f32_16x16x32_bf16 v[24:27], v[8:11], v[20:23], v[24:27]
    s_nop 7
    v_add_f32_dpp v24, v24, v24 row_ror:4 row_mask:0xf bank_mask:0xf
    v_add_f32_dpp v25, v25, v25 row_ror:4 row_mask:0xf bank_mask:0xf
    v_add_f32_dpp v26, v26, v26 row_ror:4 row_mask:0xf bank_mask:0xf
    v_add_f32_dpp v27, v27, v27 row_ror:4 row_mask:0xf bank_mask:0xf
    v_add_f32_dpp v24, v24, v24 row_ror:8 row_mask:0xf bank_mask:0xf
    v_add_f32_dpp v25, v25, v25 row_ror:8 row_mask:0xf bank_mask:0xf
    v_add_f32_dpp v26, v26, v26 row_ror:8 row_mask:0xf bank_mask:0xf
    v_add_f32_dpp v27, v27, v27 row_ror:8 row_mask:0xf bank_mask:0xf
    s_waitcnt lgkmcnt(0)
    v_pk_fma_f32 v[24:25], v[24:25], v[6:7], v[6:7] op_sel:[0,0,1] op_sel_hi:[1,0,1]
    v_pk_fma_f32 v[26:27], v[26:27], v[6:7], v[6:7] op_sel:[0,0,1] op_sel_hi:[1,0,1]
    v_and_or_b32 v24, v24, s78, v5
    v_and_or_b32 v26, v26, s78, v118
    s_mov_b64 exec, s[90:91]
    buffer_store_dwordx4 v[24:27], v14, s[28:31], 0 offen sc1
Lk_38:
    s_barrier
    s_branch L_exit
L_sub_s:
    v_add_u32 v72, 160768, v119
    v_mov_b32 v17, 160064
    ds_read_b64 v[64:65], v17
    ds_read_b128 v[16:19], v72 offset:0
    ds_read_b128 v[20:23], v72 offset:256
    ds_read_b128 v[24:27], v72 offset:512
    ds_read_b128 v[28:31], v72 offset:768
    s_waitcnt lgkmcnt(0)
    v_readfirstlane_b32 s71, v64
    v_readfirstlane_b32 s65, v65
    v_mfma_f32_16x16x32_bf16 v[32:35], v[128:131], v[16:19], 0
    v_mfma_f32_16x16x32_bf16 v[32:35], v[132:135], v[20:23], v[32:35]
    v_mfma_f32_16x16x32_bf16 v[32:35], v[136:139], v[24:27], v[32:35]
    v_mfma_f32_16x16x32_bf16 v[32:35], v[140:143], v[28:31], v[32:35]
    v_mfma_f32_16x16x32_bf16 v[40:43], v[160:163], v[16:19], 0
    v_mfma_f32_16x16x32_bf16 v[40:43], v[164:167], v[20:23], v[40:43]
    v_mfma_f32_16x16x32_bf16 v[40:43], v[168:171], v[24:27], v[40:43]
    v_mfma_f32_16x16x32_bf16 v[40:43], v[172:175], v[28:31], v[40:43]
    v_mfma_f32_16x16x32_bf16 v[48:51], v[192:195], v[16:19], 0
    v_mfma_f32_16x16x32_bf16 v[48:51], v[196:199], v[20:23], v[48:51]
    v_mfma_f32_16x16x32_bf16 v[48:51], v[200:203], v[24:27], v[48:51]
    v_mfma_f32_16x16x32_bf16 v[48:51], v[204:207], v[28:31], v[48:51]
    v_mfma_f32_16x16x32_bf16 v[56:59], v[224:227], v[16:19], 0
    v_mfma_f32_16x16x32_bf16 v[56:59], v[228:231], v[20:23], v[56:59]
    v_mfma_f32_16x16x32_bf16 v[56:59], v[232:235], v[24:27], v[56:59]
    v_mfma_f32_16x16x32_bf16 v[56:59], v[236:239], v[28:31], v[56:59]
    v_mfma_f32_16x16x32_bf16 v[36:39], v[144:147], v[16:19], 0
    v_mfma_f32_16x16x32_bf16 v[36:39], v[148:151], v[20:23], v[36:39]
    v_mfma_f32_16x16x32_bf16 v[36:39], v[152:155], v[24:27], v[36:39]
    v_mfma_f32_16x16x32_bf16 v[36:39], v[156:159], v[28:31], v[36:39]
    v_mfma_f32_16x16x32_bf16 v[44:47], v[176:179], v[16:19], 0
    v_mov_b32_dpp v32, v40 row_shr:4 row_mask:0xf bank_mask:0x2
    v_mov_b32_dpp v33, v41 row_shr:4 row_mask:0xf bank_mask:0x2
    v_mfma_f32_16x16x32_bf16 v[44:47], v[180:183], v[20:23], v[44:47]
    v_mov_b32_dpp v34, v42 row_shr:4 row_mask:0xf bank_mask:0x2
    v_mov_b32_dpp v35, v43 row_shr:4 row_mask:0xf bank_mask:0x2
    v_mfma_f32_16x16x32_bf16 v[44:47], v[184:187], v[24:27], v[44:47]
    v_mov_b32_dpp v32, v48 row_shr:8 row_mask:0xf bank_mask:0x4
    v_mov_b32_dpp v33, v49 row_shr:8 row_mask:0xf bank_mask:0x4
    v_mfma_f32_16x16x32_bf16 v[44:47], v[188:191], v[28:31], v[44:47]
    v_mov_b32_dpp v34, v50 row_shr:8 row_mask:0xf bank_mask:0x4
    v_mov_b32_dpp v35, v51 row_shr:8 row_mask:0xf bank_mask:0x4
    v_mfma_f32_16x16x32_bf16 v[52:55], v[208:211], v[16:19], 0
    v_mov_b32_dpp v32, v56 row_shr:12 row_mask:0xf bank_mask:0x8
    v_mov_b32_dpp v33, v57 row_shr:12 row_mask:0xf bank_mask:0x8
    v_mfma_f32_16x16x32_bf16 v[52:55], v[212:215], v[20:23], v[52:55]
    v_mov_b32_dpp v34, v58 row_shr:12 row_mask:0xf bank_mask:0x8
    v_mov_b32_dpp v35, v59 row_shr:12 row_mask:0xf bank_mask:0x8
    v_mfma_f32_16x16x32_bf16 v[52:55], v[216:219], v[24:27], v[52:55]
    v_max3_f32 v80, v32, v33, v34
    v_max_f32 v80, v80, v35
    v_mfma_f32_16x16x32_bf16 v[52:55], v[220:223], v[28:31], v[52:55]
    v_mfma_f32_16x16x32_bf16 v[60:63], v[240:243], v[16:19], 0
    v_mfma_f32_16x16x32_bf16 v[60:63], v[244:247], v[20:23], v[60:63]
    v_mfma_f32_16x16x32_bf16 v[60:63], v[248:251], v[24:27], v[60:63]
    v_mfma_f32_16x16x32_bf16 v[60:63], v[252:255], v[28:31], v[60:63]
    v_mov_b32_dpp v36, v44 row_shr:4 row_mask:0xf bank_mask:0x2
    v_mov_b32_dpp v37, v45 row_shr:4 row_mask:0xf bank_mask:0x2
    v_mov_b32_dpp v38, v46 row_shr:4 row_mask:0xf bank_mask:0x2
    v_mov_b32_dpp v39, v47 row_shr:4 row_mask:0xf bank_mask:0x2
    v_mov_b32_dpp v36, v52 row_shr:8 row_mask:0xf bank_mask:0x4
    v_mov_b32_dpp v37, v53 row_shr:8 row_mask:0xf bank_mask:0x4
    v_mov_b32_dpp v38, v54 row_shr:8 row_mask:0xf bank_mask:0x4
    v_mov_b32_dpp v39, v55 row_shr:8 row_mask:0xf bank_mask:0x4
    v_mov_b32_dpp v36, v60 row_shr:12 row_mask:0xf bank_mask:0x8
    v_mov_b32_dpp v37, v61 row_shr:12 row_mask:0xf bank_mask:0x8
    v_mov_b32_dpp v38, v62 row_shr:12 row_mask:0xf bank_mask:0x8
    v_mov_b32_dpp v39, v63 row_shr:12 row_mask:0xf bank_mask:0x8
    v_max3_f32 v80, v80, v36, v37
    v_max3_f32 v80, v80, v38, v39
    s_nop 1
    v_max_f32_dpp v80, v80, v80 row_ror:4 row_mask:0xf bank_mask:0xf
    s_nop 1
    v_max_f32_dpp v80, v80, v80 row_ror:8 row_mask:0xf bank_mask:0xf
    v_mov_b32 v64, v80
    s_nop 1
    v_permlane16_swap_b32 v80, v64
    v_max_f32 v80, v80, v64
    v_mov_b32 v64, v80
    s_nop 1
    v_permlane32_swap_b32 v80, v64
    v_max_f32 v80, v80, v64
    v_mul_f32_e64 v64, s71, -v80
    v_fma_f32 v32, v32, s71, v64
    v_fma_f32 v33, v33, s71, v64
    v_fma_f32 v34, v34, s71, v64
    v_fma_f32 v35, v35, s71, v64
    v_fma_f32 v36, v36, s71, v64
    v_fma_f32 v37, v37, s71, v64
    v_fma_f32 v38, v38, s71, v64
    v_fma_f32 v39, v39, s71, v64
    v_exp_f32 v32, v32
    v_exp_f32 v33, v33
    v_exp_f32 v34, v34
    v_exp_f32 v35, v35
    v_exp_f32 v36, v36
    v_exp_f32 v37, v37
    v_exp_f32 v38, v38
    v_exp_f32 v39, v39
    v_cvt_pk_bf16_f32 v72, v32, v33
    v_cvt_pk_bf16_f32 v73, v34, v35
    v_cvt_pk_bf16_f32 v74, v36, v37
    v_cvt_pk_bf16_f32 v75, v38, v39
    ds_write_b128 v116, v[72:75]
    v_pk_add_f32 v[32:33], v[32:33], v[36:37]
    v_pk_add_f32 v[34:35], v[34:35], v[38:39]
    v_pk_add_f32 v[32:33], v[32:33], v[34:35]
    v_add_f32 v69, v32, v33
    v_mov_b32 v68, v80
    s_lshl_b32 s66, s63, 9
    v_add_u32 v70, s66, v118
    ds_write_b64 v70, v[68:69]
    s_mov_b32 s47, 1
    s_setpc_b64 s[48:49]
L_sub_pv:
    ds_read_b64 v[92:93], v118 offset:0
    ds_read_b64 v[94:95], v118 offset:512
    ds_read_b64 v[96:97], v118 offset:1024
    ds_read_b64 v[98:99], v118 offset:1536
    ds_read_b128 v[16:19], v117 offset:0
    ds_read_b64_tr_b16 v[20:21], v112 offset:0
    ds_read_b64_tr_b16 v[22:23], v112 offset:4096
    ds_read_b64_tr_b16 v[24:25], v113 offset:0
    ds_read_b64_tr_b16 v[26:27], v113 offset:4096
    ds_read_b128 v[64:67], v117 offset:1024
    ds_read_b64_tr_b16 v[68:69], v112 offset:32768
    ds_read_b64_tr_b16 v[70:71], v112 offset:36864
    ds_read_b64_tr_b16 v[72:73], v113 offset:32768
    ds_read_b64_tr_b16 v[74:75], v113 offset:36864
    ds_read_b128 v[100:103], v117 offset:2048
    ds_read_b64_tr_b16 v[104:105], v114 offset:0
    ds_read_b64_tr_b16 v[106:107], v114 offset:4096
    ds_read_b64_tr_b16 v[108:109], v115 offset:0
    ds_read_b64_tr_b16 v[110:111], v115 offset:4096
    s_waitcnt lgkmcnt(10)
    v_mfma_f32_16x16x32_bf16 v[32:35], v[20:23], v[16:19], 0
    v_mfma_f32_16x16x32_bf16 v[36:39], v[24:27], v[16:19], 0
    v_max3_f32 v80, v92, v94, v96
    v_max_f32 v80, v80, v98
    v_sub_f32 v88, v92, v80
    v_sub_f32 v89, v94, v80
    v_sub_f32 v90, v96, v80
    ds_read_b128 v[16:19], v117 offset:3072
    ds_read_b64_tr_b16 v[20:21], v114 offset:32768
    ds_read_b64_tr_b16 v[22:23], v114 offset:36864
    ds_read_b64_tr_b16 v[24:25], v115 offset:32768
    ds_read_b64_tr_b16 v[26:27], v115 offset:36864
    s_waitcnt lgkmcnt(10)
    v_mfma_f32_16x16x32_bf16 v[40:43], v[68:71], v[64:67], 0
    v_mfma_f32_16x16x32_bf16 v[44:47], v[72:75], v[64:67], 0
    v_sub_f32 v91, v98, v80
    v_mul_f32 v88, s71, v88
    v_mul_f32 v89, s71, v89
    v_mul_f32 v90, s71, v90
    v_mul_f32 v91, s71, v91
    ds_read_b128 v[64:67], v117 offset:64
    ds_read_b64_tr_b16 v[68:69], v112 offset:8192
    ds_read_b64_tr_b16 v[70:71], v112 offset:12288
    ds_read_b64_tr_b16 v[72:73], v113 offset:8192
    ds_read_b64_tr_b16 v[74:75], v113 offset:12288
    s_waitcnt lgkmcnt(10)
    v_mfma_f32_16x16x32_bf16 v[48:51], v[104:107], v[100:103], 0
    v_mfma_f32_16x16x32_bf16 v[52:55], v[108:111], v[100:103], 0
    v_exp_f32 v88, v88
    v_exp_f32 v89, v89
    v_exp_f32 v90, v90
    v_exp_f32 v91, v91
    v_mul_f32 v81, v88, v93
    ds_read_b128 v[100:103], v117 offset:1088
    ds_read_b64_tr_b16 v[104:105], v112 offset:40960
    ds_read_b64_tr_b16 v[106:107], v112 offset:45056
    ds_read_b64_tr_b16 v[108:109], v113 offset:40960
    ds_read_b64_tr_b16 v[110:111], v113 offset:45056
    s_waitcnt lgkmcnt(10)
    v_mfma_f32_16x16x32_bf16 v[56:59], v[20:23], v[16:19], 0
    v_mfma_f32_16x16x32_bf16 v[60:63], v[24:27], v[16:19], 0
    v_fmac_f32 v81, v89, v95
    v_fmac_f32 v81, v90, v97
    v_fmac_f32 v81, v91, v99
    s_nop 1
    v_add_f32_dpp v81, v81, v81 row_ror:4 row_mask:0xf bank_mask:0xf
    s_nop 1
    v_add_f32_dpp v81, v81, v81 row_ror:8 row_mask:0xf bank_mask:0xf
    ds_read_b128 v[16:19], v117 offset:2112
    ds_read_b64_tr_b16 v[20:21], v114 offset:8192
    ds_read_b64_tr_b16 v[22:23], v114 offset:12288
    ds_read_b64_tr_b16 v[24:25], v115 offset:8192
    ds_read_b64_tr_b16 v[26:27], v115 offset:12288
    s_waitcnt lgkmcnt(10)
    v_mfma_f32_16x16x32_bf16 v[32:35], v[68:71], v[64:67], v[32:35]
    v_mfma_f32_16x16x32_bf16 v[36:39], v[72:75], v[64:67], v[36:39]
    v_mov_b32 v84, v81
    s_nop 1
    v_permlane16_swap_b32 v81, v84
    v_add_f32 v81, v81, v84
    v_mov_b32 v84, v81
    s_nop 1
    v_permlane32_swap_b32 v81, v84
    ds_read_b128 v[64:67], v117 offset:3136
    ds_read_b64_tr_b16 v[68:69], v114 offset:40960
    ds_read_b64_tr_b16 v[70:71], v114 offset:45056
    ds_read_b64_tr_b16 v[72:73], v115 offset:40960
    ds_read_b64_tr_b16 v[74:75], v115 offset:45056
    s_waitcnt lgkmcnt(10)
    v_mfma_f32_16x16x32_bf16 v[40:43], v[104:107], v[100:103], v[40:43]
    v_mfma_f32_16x16x32_bf16 v[44:47], v[108:111], v[100:103], v[44:47]
    v_add_f32 v81, v81, v84
    v_rcp_f32 v85, v81
    v_log_f32 v86, v81
    v_mul_f32 v88, v88, v85
    v_mul_f32 v89, v89, v85
    s_waitcnt lgkmcnt(5)
    v_mfma_f32_16x16x32_bf16 v[48:51], v[20:23], v[16:19], v[48:51]
    v_mfma_f32_16x16x32_bf16 v[52:55], v[24:27], v[16:19], v[52:55]
    v_mul_f32 v90, v90, v85
    v_mul_f32 v91, v91, v85
    v_fma_f32 v124, v80, s71, v86
    v_mov_b32 v125, v3
    v_mov_b32 v126, v3
    s_waitcnt lgkmcnt(0)
    v_mfma_f32_16x16x32_bf16 v[56:59], v[68:71], v[64:67], v[56:59]
    v_mfma_f32_16x16x32_bf16 v[60:63], v[72:75], v[64:67], v[60:63]
    v_mov_b32 v127, v3
    s_mov_b32 s47, 3
    s_setpc_b64 s[48:49]
L_B:
    s_load_dwordx2 s[12:13], s[0:1], 32
    s_load_dwordx8 s[16:23], s[0:1], 48
    s_setprio 3
    v_lshlrev_b32 v3, 4, v13
    v_lshl_add_u32 v2, v12, 13, v3
    v_lshlrev_b32 v122, 4, v1
    v_lshrrev_b32 v5, 3, v1
    v_and_b32 v6, 7, v1
    v_mul_u32_u24 v4, 3584, v5
    v_lshl_add_u32 v4, v6, 4, v4
    v_and_b32 v14, 3, v1
    v_lshlrev_b32 v8, 3, v12
    v_lshl_add_u32 v8, v14, 10, v8
    v_lshl_add_u32 v115, s61, 5, v8
    s_lshl_b32 s69, s63, 12
    s_lshl_b32 s68, s63, 10
    s_lshl_b32 s66, s61, 7
    s_add_u32 s66, s66, s60
    s_lshl_b32 s66, s66, 2
    s_add_u32 s66, s66, s63
    s_lshl_b32 s66, s66, 8
    s_cmp_lg_u32 s63, 0
    s_cbranch_scc1 Lk_40
    v_mov_b32 v9, 159944
    v_mov_b32 v10, 0
    v_mov_b32 v11, 0
    ds_write_b64 v9, v[10:11]
Lk_40:
    s_add_u32 m0, s69, 131072
    s_mov_b32 s50, 4096
    s_mov_b32 s51, 0x20000
    s_mov_b32 s34, 4194304
    s_mov_b32 s35, 0x20000
    s_waitcnt lgkmcnt(0)
    s_mov_b64 s[32:33], s[10:11]
    s_mov_b64 s[48:49], s[4:5]
    buffer_load_dwordx4 v[16:19], v122, s[48:51], s68 offen nt
    buffer_load_dwordx2 v[32:33], v115, s[48:51], 0 offen nt
    buffer_load_dwordx4 v2, s[32:35], s66 offen nt lds
    s_add_u32 m0, m0, 1024
    s_add_u32 s66, s66, 32768
    buffer_load_dwordx4 v2, s[32:35], s66 offen nt lds
    s_add_u32 m0, m0, 1024
    s_add_u32 s66, s66, 32768
    buffer_load_dwordx4 v2, s[32:35], s66 offen nt lds
    s_add_u32 m0, m0, 1024
    s_add_u32 s66, s66, 32768
    buffer_load_dwordx4 v2, s[32:35], s66 offen nt lds
    s_load_dword s64, s[26:27], 0
    s_mov_b32 s28, s26
    s_mov_b32 s29, s27
    s_mov_b32 s30, 6291456
    s_mov_b32 s31, 0x20000
    s_cmp_lg_u32 s63, 1
    s_cbranch_scc1 Lk_41
    s_getpc_b64 s[56:57]
L_pc:
    s_sub_u32 s56, s56, L_pc-interleave_layers__sliding_block_cached__glu_gated_reglu__decode_kernel
    s_subb_u32 s57, s57, 0
    s_lshl_b32 s66, s61, 10
    s_min_u32 s66, s66, L_codeend-interleave_layers__sliding_block_cached__glu_gated_reglu__decode_kernel-1024
    v_add_u32 v9, s66, v122
    global_load_dwordx4 v[124:127], v9, s[56:57]
Lk_41:
    s_mov_b32 s36, s16
    s_mov_b32 s37, s17
    s_mov_b32 s38, 1835008
    s_mov_b32 s39, 0x20000
    s_mov_b32 s40, s18
    s_mov_b32 s41, s19
    s_mov_b32 s42, 1835008
    s_mov_b32 s43, 0x20000
    s_mul_i32 s66, s61, 57344
    s_mul_i32 s67, s60, 448
    s_add_u32 s66, s66, s67
    s_lshl_b32 s67, s63, 7
    s_add_u32 s66, s66, s67
    s_mov_b32 s84, 0xf0f0f0f
    s_mov_b32 s85, 0xf0f0f0f
    s_cmp_eq_u32 s63, 3
    s_cselect_b64 exec, s[84:85], -1
    s_add_u32 m0, s69, 147456
    s_add_u32 s67, s66, 0
    buffer_load_dwordx4 v4, s[36:39], s67 offen nt lds
    s_add_u32 m0, s69, 148480
    s_add_u32 s67, s66, 28672
    buffer_load_dwordx4 v4, s[36:39], s67 offen nt lds
    s_add_u32 m0, s69, 149504
    s_add_u32 s67, s66, 0
    buffer_load_dwordx4 v4, s[40:43], s67 offen nt lds
    s_add_u32 m0, s69, 150528
    s_add_u32 s67, s66, 28672
    buffer_load_dwordx4 v4, s[40:43], s67 offen nt lds
    s_mov_b64 exec, -1
    s_cmp_lt_u32 s63, 2
    s_cbranch_scc1 Lk_42
    s_cmp_lg_u32 s61, 0
    s_cbranch_scc1 Lk_42
    s_and_b32 s66, s63, 1
    s_lshl1_add_u32 s58, s60, s66
    s_lshl_b32 s58, s58, 13
    s_add_u32 s58, s58, 4194304
    s_mov_b32 s59, 4095
    s_load_dword s56, s[26:27], s58
    s_waitcnt lgkmcnt(0)
    s_add_u32 s58, s58, 1152
    s_memtime s[96:97]
    s_waitcnt lgkmcnt(0)
    s_load_dword s56, s[26:27], s58
    s_waitcnt lgkmcnt(0)
    s_memtime s[56:57]
    s_waitcnt lgkmcnt(0)
    s_sub_u32 s56, s56, s96
    s_min_u32 s59, s59, s56
    s_add_u32 s58, s58, 1152
    s_memtime s[96:97]
    s_waitcnt lgkmcnt(0)
    s_load_dword s56, s[26:27], s58
    s_waitcnt lgkmcnt(0)
    s_memtime s[56:57]
    s_waitcnt lgkmcnt(0)
    s_sub_u32 s56, s56, s96
    s_min_u32 s59, s59, s56
Lk_42:
    s_getreg_b32 s66, hwreg(HW_REG_XCC_ID, 0, 4)
    s_and_b32 s66, s66, 7
    s_lshl_b32 s101, s60, 12
    s_add_u32 s101, s101, 229376
    s_waitcnt lgkmcnt(0)
    s_mul_i32 s95, s64, 0x9e3779b1
    s_add_u32 s95, s95, 0x7f4a7c15
    s_or_b32 s95, s95, 8
    s_and_b32 s100, s95, -8
    s_or_b32 s100, s100, s66
    s_cmp_lg_u32 s63, 1
    s_cbranch_scc1 Lk_43
    s_lshl_b32 s66, s61, 2
    v_mov_b32 v44, s66
    v_mov_b32 v45, s100
    s_mov_b64 exec, 1
    buffer_store_dword v45, v44, s[28:31], s101 offen sc1
    s_mov_b64 exec, -1
Lk_43:
    s_cmp_lg_u32 s63, 2
    s_cbranch_scc1 Lk_44
    v_mov_b32 v9, 159968
    v_mov_b32 v44, s95
    v_mov_b32 v45, s59
    ds_write_b64 v9, v[44:45]
Lk_44:
    s_mul_i32 s72, s60, 135168
    s_add_u32 s72, s72, 1310720
    s_mov_b32 s74, 0xfffefffe
    v_bfe_u32 v46, v1, 2, 2
    v_lshlrev_b32 v47, 4, v14
    v_lshl_add_u32 v47, v12, 6, v47
    v_lshl_add_u32 v102, v46, 8, v47
    s_add_u32 s66, s69, 131072
    v_add_u32 v102, s66, v102
    v_lshl_add_u32 v48, s63, 3, v5
    v_mul_u32_u24 v105, 4224, v48
    v_lshl_add_u32 v105, v6, 4, v105
    v_lshl_add_u32 v105, s61, 7, v105
    s_lshr_b32 s66, s100, 8
    s_and_b32 s66, s66, 0x10001
    v_mov_b32 v84, 0
    s_xor_b32 s67, s66, 0x1
    v_mov_b32 v85, s67
    s_xor_b32 s67, s66, 0x10000
    v_mov_b32 v86, s67
    s_xor_b32 s67, s66, 0x10001
    v_mov_b32 v87, s67
    v_mov_b32 v34, 0x3f803f80
    s_waitcnt vmcnt(8)
    v_dot2_f32_bf16 v35, v16, v34, 0
    v_dot2_f32_bf16 v35, v17, v34, v35
    v_dot2_f32_bf16 v35, v18, v34, v35
    v_dot2_f32_bf16 v35, v19, v34, v35
    v_dot2_f32_bf16 v36, v16, v16, 0
    v_dot2_f32_bf16 v36, v17, v17, v36
    v_dot2_f32_bf16 v36, v18, v18, v36
    v_dot2_f32_bf16 v36, v19, v19, v36
    v_add_f32_dpp v35, v35, v35 quad_perm:[1,0,3,2] row_mask:0xf bank_mask:0xf
    s_nop 1
    v_add_f32_dpp v36, v36, v36 quad_perm:[1,0,3,2] row_mask:0xf bank_mask:0xf
    v_add_f32_dpp v35, v35, v35 quad_perm:[2,3,0,1] row_mask:0xf bank_mask:0xf
    s_nop 0
    v_add_f32_dpp v36, v36, v36 quad_perm:[2,3,0,1] row_mask:0xf bank_mask:0xf
    v_add_f32_dpp v35, v35, v35 row_ror:4 row_mask:0xf bank_mask:0xf
    s_nop 0
    v_add_f32_dpp v36, v36, v36 row_ror:4 row_mask:0xf bank_mask:0xf
    v_add_f32_dpp v35, v35, v35 row_ror:8 row_mask:0xf bank_mask:0xf
    s_nop 0
    v_add_f32_dpp v36, v36, v36 row_ror:8 row_mask:0xf bank_mask:0xf
    v_mov_b32 v37, v35
    s_nop 1
    v_permlane16_swap_b32 v35, v37
    v_add_f32 v35, v35, v37
    v_mov_b32 v37, v35
    s_nop 1
    v_permlane32_swap_b32 v35, v37
    v_add_f32 v35, v35, v37
    v_mov_b32 v37, v36
    s_nop 1
    v_permlane16_swap_b32 v36, v37
    v_add_f32 v36, v36, v37
    v_mov_b32 v37, v36
    s_nop 1
    v_permlane32_swap_b32 v36, v37
    v_add_f32 v36, v36, v37
    v_mul_f32 v40, 0x3b000000, v35
    v_mul_f32 v37, v40, v40
    v_mov_b32 v38, 0x3b000000
    v_fma_f32 v36, v36, v38, -v37
    v_max_f32 v36, 0, v36
    v_add_f32 v36, 0x3727c5ac, v36
    v_rsq_f32 v36, v36
    s_nop 0
    v_mul_f32 v41, 0x3e0293ee, v36
    v_mov_b32 v42, s95
    v_mov_b32 v43, 0
    s_lshl_b32 s66, s63, 4
    s_add_u32 s66, s66, 159808
    v_mov_b32 v37, s66
    ds_write_b128 v37, v[40:43]
    v_lshlrev_b32 v37, 4, v14
    v_add_u32 v37, 159808, v37
    v_lshlrev_b32 v208, 16, v32
    v_and_b32 v209, 0xffff0000, v32
    v_lshlrev_b32 v210, 16, v33
    v_and_b32 v211, 0xffff0000, v33
    s_mov_b32 s70, 0
Lh_45:
    ds_read_b128 v[40:43], v37
    s_add_u32 s70, s70, 1
    s_cmp_gt_u32 s70, 0x8000
    s_cbranch_scc1 L_fail
    s_waitcnt lgkmcnt(0)
    v_cmp_ne_u32 vcc, s95, v42
    s_cbranch_vccnz Lh_45
    v_readlane_b32 s71, v41, s62
    v_sub_f32 v208, v208, v40
    v_sub_f32 v209, v209, v40
    v_sub_f32 v210, v210, v40
    v_sub_f32 v211, v211, v40
    v_cvt_pk_bf16_f32 v212, v208, v209
    v_cvt_pk_bf16_f32 v213, v210, v211
    v_mov_b32 v112, v40
    s_waitcnt vmcnt(4)
    ds_read_b64_tr_b16 v[128:129], v102 offset:0
    ds_read_b64_tr_b16 v[130:131], v102 offset:1024
    ds_read_b64_tr_b16 v[132:133], v102 offset:2048
    ds_read_b64_tr_b16 v[134:135], v102 offset:3072
    ds_read_b64_tr_b16 v[136:137], v102 offset:8
    ds_read_b64_tr_b16 v[138:139], v102 offset:1032
    ds_read_b64_tr_b16 v[140:141], v102 offset:2056
    ds_read_b64_tr_b16 v[142:143], v102 offset:3080
    s_waitcnt lgkmcnt(0)
    v_mfma_f32_4x4x4_16b_bf16 v[216:219], v[128:129], v[212:213], 0 blgp:4
    v_mfma_f32_4x4x4_16b_bf16 v[220:223], v[136:137], v[212:213], 0 blgp:4
    s_nop 0
    v_mfma_f32_4x4x4_16b_bf16 v[216:219], v[130:131], v[212:213], v[216:219] blgp:5
    v_mfma_f32_4x4x4_16b_bf16 v[220:223], v[138:139], v[212:213], v[220:223] blgp:5
    s_nop 0
    v_mfma_f32_4x4x4_16b_bf16 v[216:219], v[132:133], v[212:213], v[216:219] blgp:6
    v_mfma_f32_4x4x4_16b_bf16 v[220:223], v[140:141], v[212:213], v[220:223] blgp:6
    s_nop 0
    v_mfma_f32_4x4x4_16b_bf16 v[216:219], v[134:135], v[212:213], v[216:219] blgp:7
    v_mfma_f32_4x4x4_16b_bf16 v[220:223], v[142:143], v[212:213], v[220:223] blgp:7
    s_nop 3
    v_cvt_pk_bf16_f32 v248, v216, v217
    v_cvt_pk_bf16_f32 v249, v218, v219
    v_cvt_pk_bf16_f32 v250, v220, v221
    v_cvt_pk_bf16_f32 v251, v222, v223
    v_and_or_b32 v248, v248, s74, v84
    v_and_or_b32 v249, v249, s74, v85
    v_and_or_b32 v250, v250, s74, v86
    v_and_or_b32 v251, v251, s74, v87
    buffer_store_dwordx4 v[248:251], v105, s[28:31], s72 offen
    s_mov_b32 s28, s26
    s_mov_b32 s29, s27
    s_mov_b32 s30, 6291456
    s_mov_b32 s31, 0x20000
    s_mul_i32 s72, s60, 135168
    s_add_u32 s72, s72, 1310720
    s_add_u32 s73, s72, 67584
    s_mul_i32 s75, s60, 81920
    s_add_u32 s75, s75, 524288
    s_lshl_b32 s76, s60, 12
    s_add_u32 s76, s76, 65536
    s_lshl_b32 s77, s60, 10
    s_add_u32 s77, s77, 131072
    s_add_u32 s80, s60, 0
    s_and_b32 s80, s80, 3
    s_lshl_b32 s80, s80, 11
    s_add_u32 s80, s80, 4194304
    s_add_u32 s81, s60, 1
    s_and_b32 s81, s81, 3
    s_lshl_b32 s81, s81, 11
    s_add_u32 s81, s81, 4194304
    s_add_u32 s82, s60, 2
    s_and_b32 s82, s82, 3
    s_lshl_b32 s82, s82, 11
    s_add_u32 s82, s82, 4194304
    s_add_u32 s83, s60, 3
    s_and_b32 s83, s83, 3
    s_lshl_b32 s83, s83, 11
    s_add_u32 s83, s83, 4194304
    s_mov_b32 s78, 0xffffff00
    s_mov_b32 s74, 0xfffefffe
    s_mov_b32 s94, 0xfffff000
    s_mov_b32 s88, 0xf000f
    s_mov_b32 s89, 0xf000f
    s_mov_b32 s52, s22
    s_mov_b32 s53, s23
    s_mov_b32 s54, 4096
    s_mov_b32 s55, 0x20000
    s_mov_b32 s44, s20
    s_mov_b32 s45, s21
    s_mov_b32 s46, 1835008
    s_mov_b32 s47, 0x20000
    v_and_b32 v43, 1, v14
    v_lshlrev_b32 v43, 11, v43
    v_lshl_add_u32 v43, v46, 7, v43
    v_lshl_add_u32 v43, v12, 5, v43
    v_lshrrev_b32 v44, 1, v14
    v_lshl_add_u32 v43, v44, 4, v43
    s_add_u32 s66, s69, 147456
    v_add_u32 v103, s66, v43
    v_lshl_add_u32 v43, v46, 10, v47
    v_add_u32 v104, 147456, v43
    s_lshl_b32 s66, s63, 8
    s_add_u32 s66, s66, 131072
    v_add_u32 v111, s66, v43
    s_mul_i32 s67, s61, 4224
    v_add_u32 v116, s67, v122
    v_lshl_add_u32 v106, s63, 10, v116
    v_lshl_add_u32 v45, v46, 8, v47
    s_and_b32 s67, s60, 3
    s_lshl2_add_u32 s66, s61, s67
    s_lshl_b32 s66, s66, 14
    v_add_u32 v107, s66, v45
    v_mul_u32_u24 v44, 320, v46
    v_lshl_add_u32 v44, v14, 4, v44
    s_mul_i32 s66, s61, 2560
    v_add_u32 v109, s66, v44
    v_lshl_add_u32 v108, v12, 6, v109
    v_lshlrev_b32 v44, 2, v14
    v_lshl_add_u32 v110, s61, 4, v44
    v_and_b32 v121, 31, v1
    v_lshlrev_b32 v121, 2, v121
    s_cmp_eq_u32 s63, 3
    s_cselect_b32 s87, 0, -1
    s_mov_b32 s86, -1
    s_and_b32 s66, s61, 7
    s_lshl_b32 s66, s66, 7
    s_lshl_b32 s67, s62, 4
    s_add_u32 s66, s66, s67
    v_bfe_u32 v44, v1, 2, 1
    v_lshlrev_b32 v44, 6, v44
    v_lshl_add_u32 v44, v12, 3, v44
    v_lshl_add_u32 v44, v14, 10, v44
    v_add_u32 v44, s66, v44
    v_lshlrev_b32 v101, 1, v44
    v_and_b32 v44, 1, v1
    v_lshlrev_b32 v44, 4, v44
    v_mov_b32 v45, 0x3f80
    v_lshlrev_b32 v44, v44, v45
    v_bfe_u32 v45, v1, 1, 2
    v_cmp_eq_u32 vcc, 0, v45
    s_nop 1
    v_cndmask_b32 v88, 0, v44, vcc
    v_cmp_eq_u32 vcc, 1, v45
    s_nop 1
    v_cndmask_b32 v89, 0, v44, vcc
    v_cmp_eq_u32 vcc, 2, v45
    s_nop 1
    v_cndmask_b32 v90, 0, v44, vcc
    v_cmp_eq_u32 vcc, 3, v45
    s_nop 1
    v_cndmask_b32 v91, 0, v44, vcc
    s_bfe_u32 s66, s64, 0x70007
    v_mov_b32 v123, s66
    s_waitcnt vmcnt(1)
    ds_read_b64_tr_b16 v[144:145], v103 offset:0
    ds_read_b64_tr_b16 v[146:147], v103 offset:512
    ds_read_b64_tr_b16 v[148:149], v103 offset:1024
    ds_read_b64_tr_b16 v[150:151], v103 offset:1536
    ds_read_b64_tr_b16 v[152:153], v103 offset:8
    ds_read_b64_tr_b16 v[154:155], v103 offset:520
    ds_read_b64_tr_b16 v[156:157], v103 offset:1032
    ds_read_b64_tr_b16 v[158:159], v103 offset:1544
    s_waitcnt lgkmcnt(0)
    v_mov_b32 v9, 159944
    v_mov_b32 v10, 1
    s_mov_b64 exec, 1
    ds_add_u32 v9, v10 offset:0
    s_mov_b64 exec, -1
    s_cmp_lg_u32 s63, 3
    s_cbranch_scc1 Lk_46
    s_cmp_lg_u32 s61, 0
    s_cbranch_scc1 Lk_47
    v_mov_b32 v9, 159968
    s_mov_b32 s70, 0
Lh_48:
    s_sleep 0
    ds_read_b64 v[44:45], v9
    s_add_u32 s70, s70, 1
    s_cmp_gt_u32 s70, 0x4000
    s_cbranch_scc1 L_fail
    s_waitcnt lgkmcnt(0)
    v_cmp_ne_u32 vcc, s95, v44
    s_cbranch_vccnz Lh_48
    v_sub_u32 v45, s59, v45
    v_ashrrev_i32 v45, 1, v45
    v_and_b32 v45, 0xfff, v45
    s_and_b32 s66, s95, 0xfffff000
    v_or_b32 v45, s66, v45
    s_lshl_b32 s66, s60, 3
    s_add_u32 s66, s66, 225280
    v_mov_b32 v9, s66
    v_mov_b32 v44, s100
    s_mov_b64 exec, 1
    buffer_store_dwordx2 v[44:45], v9, s[28:31], 0 offen sc1
    s_mov_b64 exec, -1
Lk_47:
Lk_46:
    s_cmp_eq_u32 s63, 0
    s_cbranch_scc1 Lw_49
    s_mov_b32 s70, 0
    s_sleep 90
Lp_51:
    buffer_load_dword v48, v121, s[28:31], s101 offen nt
    s_waitcnt vmcnt(0)
    v_xor_b32 v119, s100, v48
    v_cmp_ne_u32 vcc, 0, v119
    s_nop 0
    s_cmp_eq_u64 vcc, 0
    s_cselect_b32 s65, 1, 0
    v_cmp_lt_u32 vcc, 7, v119
    s_cbranch_vccz Lo_52
    s_sleep 8
    s_add_u32 s70, s70, 1
    s_cmp_gt_u32 s70, 0x1000
    s_cbranch_scc1 L_fail
    s_branch Lp_51
Lo_52:
    s_cmp_lg_u32 s65, 0
    s_cbranch_scc1 Lk_53
    buffer_store_dwordx4 v[248:251], v105, s[28:31], s72 offen sc1
Lk_53:
    s_cmp_lg_u32 s63, 2
    s_cbranch_scc1 Lk_54
    v_lshlrev_b32 v9, 3, v6
    s_mov_b32 s68, 225280
    v_mov_b32 v24, s95
    s_mov_b32 s70, 0
    s_sleep 30
Lp_55:
    buffer_load_dwordx2 v[16:17], v9, s[28:31], s68 offen sc1
    s_waitcnt vmcnt(0)
    v_xor_b32 v18, v16, v24
    v_xor_b32 v19, v17, v24
    v_and_b32 v19, 0xfffff000, v19
    v_or_b32 v18, v18, v19
    v_cmp_lt_u32 vcc, 7, v18
    s_cbranch_vccz Lo_56
    s_sleep 16
    s_add_u32 s70, s70, 1
    s_cmp_gt_u32 s70, 0x1000
    s_cbranch_scc1 L_fail
    s_branch Lp_55
Lo_56:
    v_bfe_i32 v17, v17, 0, 12
    v_bfe_i32 v26, v16, 2, 1
    v_xor_b32 v17, v17, v26
    v_sub_u32 v17, v17, v26
    s_nop 1
    v_add_u32_dpp v17, v17, v17 quad_perm:[1,0,3,2] row_mask:0xf bank_mask:0xf
    s_nop 1
    v_add_u32_dpp v17, v17, v17 quad_perm:[2,3,0,1] row_mask:0xf bank_mask:0xf
    s_nop 1
    v_add_u32_dpp v17, v17, v17 row_ror:4 row_mask:0xf bank_mask:0xf
    v_cmp_ne_u32 vcc, 0, v26
    v_readfirstlane_b32 s68, v17
    s_and_b32 s66, vcc_lo, 15
    s_bfe_u32 s67, vcc_lo, 0x40004
    s_xor_b32 s56, s66, s67
    s_lshl4_add_u32 s66, s67, s66
    s_cmp_eq_u32 s56, 15
    s_cselect_b32 s66, s66, 0xf0
    s_cmp_gt_i32 s68, 0
    s_cselect_b32 s67, 0, 0xff
    s_xor_b32 s66, s66, s67
    v_mov_b32 v9, 160072
    v_mov_b32 v16, s66
    ds_write_b32 v9, v16
Lk_54:
    s_cmp_lg_u32 s63, 1
    s_cbranch_scc1 Lj_50
    v_mov_b32 v10, -1
    v_bfe_u32 v9, v1, 3, 2
    v_lshlrev_b32 v9, 10, v9
    v_lshl_add_u32 v9, v14, 2, v9
    v_bfe_u32 v11, v1, 2, 1
    v_lshl_add_u32 v9, v11, 6, v9
    s_and_b32 s68, s61, 7
    s_lshl_b32 s68, s68, 7
    s_lshl_b32 s67, s62, 4
    s_add_u32 s68, s68, s67
    s_add_u32 s68, s68, s76
    s_mov_b32 exec_hi, 0
    s_cmp_eq_u32 s65, 0
    s_cbranch_scc1 Ls_57
    buffer_store_dword v10, v9, s[28:31], s68 offen
Lb_58:
    s_mov_b64 exec, -1
    s_branch Lj_50
Lw_49:
    s_mov_b32 s56, 0
    s_mov_b32 s70, 0
    s_sleep 12
Lp_59:
    buffer_load_dword v48, v121, s[28:31], s101 offen nt
    buffer_load_dwordx4 v[16:19], v116, s[28:31], s72 offen offset:0 nt
    buffer_load_dwordx4 v[20:23], v116, s[28:31], s72 offen offset:1024 nt
    buffer_load_dwordx4 v[24:27], v116, s[28:31], s72 offen offset:2048 nt
    buffer_load_dwordx4 v[28:31], v116, s[28:31], s72 offen offset:3072 nt
    s_waitcnt vmcnt(0)
    v_xor_b32 v119, s100, v48
    v_cmp_ne_u32 vcc, 0, v119
    s_nop 0
    s_cmp_eq_u64 vcc, 0
    s_cselect_b32 s65, 1, 0
    v_cmp_lt_u32 vcc, 7, v119
    s_nop 0
    s_mov_b64 s[84:85], vcc
    s_cbranch_vccnz Lb_61
    s_or_b32 s66, s65, s56
    s_cbranch_scc1 Lb_61
    buffer_store_dwordx4 v[248:251], v105, s[28:31], s72 offen sc1
    s_mov_b32 s56, 1
Lb_61:
    v_xor_b32 v119, v16, v84
    v_bitop3_b32 v119, v119, v17, v85 bitop3:0xf6
    v_bitop3_b32 v119, v119, v18, v86 bitop3:0xf6
    v_bitop3_b32 v119, v119, v19, v87 bitop3:0xf6
    v_bitop3_b32 v119, v119, v20, v84 bitop3:0xf6
    v_bitop3_b32 v119, v119, v21, v85 bitop3:0xf6
    v_bitop3_b32 v119, v119, v22, v86 bitop3:0xf6
    v_bitop3_b32 v119, v119, v23, v87 bitop3:0xf6
    v_bitop3_b32 v119, v119, v24, v84 bitop3:0xf6
    v_bitop3_b32 v119, v119, v25, v85 bitop3:0xf6
    v_bitop3_b32 v119, v119, v26, v86 bitop3:0xf6
    v_bitop3_b32 v119, v119, v27, v87 bitop3:0xf6
    v_bitop3_b32 v119, v119, v28, v84 bitop3:0xf6
    v_bitop3_b32 v119, v119, v29, v85 bitop3:0xf6
    v_bitop3_b32 v119, v119, v30, v86 bitop3:0xf6
    v_bitop3_b32 v119, v119, v31, v87 bitop3:0xf6
    v_and_b32 v119, 0x10001, v119
    v_cmp_ne_u32 vcc, 0, v119
    s_nop 0
    s_or_b64 vcc, vcc, s[84:85]
    s_cbranch_vccz Lo_60
    s_sleep 4
    s_add_u32 s70, s70, 1
    s_cmp_gt_u32 s70, 0x1000
    s_cbranch_scc1 L_fail
    s_branch Lp_59
Lo_60:
    v_mfma_f32_16x16x32_bf16 v[32:35], v[88:91], v[16:19], 0
    v_mfma_f32_16x16x32_bf16 v[32:35], v[88:91], v[20:23], v[32:35]
    v_mfma_f32_16x16x32_bf16 v[32:35], v[88:91], v[24:27], v[32:35]
    v_mfma_f32_16x16x32_bf16 v[32:35], v[88:91], v[28:31], v[32:35]
    s_nop 7
    v_add_f32_dpp v32, v32, v32 row_ror:8 row_mask:0xf bank_mask:0xf
    v_add_f32_dpp v33, v33, v33 row_ror:8 row_mask:0xf bank_mask:0xf
    v_add_f32_dpp v34, v34, v34 row_ror:8 row_mask:0xf bank_mask:0xf
    v_add_f32_dpp v35, v35, v35 row_ror:8 row_mask:0xf bank_mask:0xf
    s_lshr_b32 s66, s100, 16
    v_mov_b32 v49, s66
    s_mov_b32 s67, 0x07060100
    v_cvt_pk_bf16_f32 v32, v32, v32
    v_cvt_pk_bf16_f32 v33, v33, v33
    v_cvt_pk_bf16_f32 v34, v34, v34
    v_cvt_pk_bf16_f32 v35, v35, v35
    v_perm_b32 v32, v32, v49, s67
    v_perm_b32 v33, v33, v49, s67
    v_perm_b32 v34, v34, v49, s67
    v_perm_b32 v35, v35, v49, s67
    s_lshl_b32 s68, s60, 13
    s_add_u32 s68, s68, 262144
    s_mov_b64 exec, 0xff00ff
    s_cmp_eq_u32 s65, 0
    s_cbranch_scc1 Ls_62
    buffer_store_dwordx4 v[32:35], v101, s[28:31], s68 offen
Lb_63:
    s_mov_b64 exec, -1
    s_lshl_b32 s66, s62, 11
    s_add_u32 s68, s68, s66
    v_lshlrev_b32 v9, 5, v1
    s_mov_b32 s70, 0
    s_sleep 12
    buffer_load_dwordx4 v[216:219], v9, s[28:31], s68 offen offset:0 nt
    buffer_load_dwordx4 v[220:223], v9, s[28:31], s68 offen offset:16 nt
    s_sleep 14
    buffer_load_dwordx4 v[224:227], v9, s[28:31], s68 offen offset:0 nt
    buffer_load_dwordx4 v[228:231], v9, s[28:31], s68 offen offset:16 nt
    s_sleep 14
Lq_64:
    buffer_load_dwordx4 v[232:235], v9, s[28:31], s68 offen offset:0 nt
    buffer_load_dwordx4 v[236:239], v9, s[28:31], s68 offen offset:16 nt
    s_waitcnt vmcnt(4)
    v_xor_b32 v119, v216, v49
    v_bitop3_b32 v119, v119, v217, v49 bitop3:0xf6
    v_bitop3_b32 v119, v119, v218, v49 bitop3:0xf6
    v_bitop3_b32 v119, v119, v219, v49 bitop3:0xf6
    v_bitop3_b32 v119, v119, v220, v49 bitop3:0xf6
    v_bitop3_b32 v119, v119, v221, v49 bitop3:0xf6
    v_bitop3_b32 v119, v119, v222, v49 bitop3:0xf6
    v_bitop3_b32 v119, v119, v223, v49 bitop3:0xf6
    v_and_b32 v119, 0xffff, v119
    v_cmp_ne_u32 vcc, 0, v119
    s_cbranch_vccz Lo_66
    buffer_load_dwordx4 v[216:219], v9, s[28:31], s68 offen offset:0 nt
    buffer_load_dwordx4 v[220:223], v9, s[28:31], s68 offen offset:16 nt
    s_waitcnt vmcnt(4)
    v_xor_b32 v119, v224, v49
    v_bitop3_b32 v119, v119, v225, v49 bitop3:0xf6
    v_bitop3_b32 v119, v119, v226, v49 bitop3:0xf6
    v_bitop3_b32 v119, v119, v227, v49 bitop3:0xf6
    v_bitop3_b32 v119, v119, v228, v49 bitop3:0xf6
    v_bitop3_b32 v119, v119, v229, v49 bitop3:0xf6
    v_bitop3_b32 v119, v119, v230, v49 bitop3:0xf6
    v_bitop3_b32 v119, v119, v231, v49 bitop3:0xf6
    v_and_b32 v119, 0xffff, v119
    v_cmp_ne_u32 vcc, 0, v119
    s_cbranch_vccz Lo_67
    buffer_load_dwordx4 v[224:227], v9, s[28:31], s68 offen offset:0 nt
    buffer_load_dwordx4 v[228:231], v9, s[28:31], s68 offen offset:16 nt
    s_waitcnt vmcnt(4)
    v_xor_b32 v119, v232, v49
    v_bitop3_b32 v119, v119, v233, v49 bitop3:0xf6
    v_bitop3_b32 v119, v119, v234, v49 bitop3:0xf6
    v_bitop3_b32 v119, v119, v235, v49 bitop3:0xf6
    v_bitop3_b32 v119, v119, v236, v49 bitop3:0xf6
    v_bitop3_b32 v119, v119, v237, v49 bitop3:0xf6
    v_bitop3_b32 v119, v119, v238, v49 bitop3:0xf6
    v_bitop3_b32 v119, v119, v239, v49 bitop3:0xf6
    v_and_b32 v119, 0xffff, v119
    v_cmp_ne_u32 vcc, 0, v119
    s_cbranch_vccz Lo_68
    s_add_u32 s70, s70, 1
    s_cmp_gt_u32 s70, 0x1000
    s_cbranch_scc1 L_fail
    s_branch Lq_64
Lo_66:
    v_mov_b32 v24, v216
    v_mov_b32 v25, v217
    v_mov_b32 v26, v218
    v_mov_b32 v27, v219
    v_mov_b32 v28, v220
    v_mov_b32 v29, v221
    v_mov_b32 v30, v222
    v_mov_b32 v31, v223
    s_branch Ld_65
Lo_67:
    v_mov_b32 v24, v224
    v_mov_b32 v25, v225
    v_mov_b32 v26, v226
    v_mov_b32 v27, v227
    v_mov_b32 v28, v228
    v_mov_b32 v29, v229
    v_mov_b32 v30, v230
    v_mov_b32 v31, v231
    s_branch Ld_65
Lo_68:
    v_mov_b32 v24, v232
    v_mov_b32 v25, v233
    v_mov_b32 v26, v234
    v_mov_b32 v27, v235
    v_mov_b32 v28, v236
    v_mov_b32 v29, v237
    v_mov_b32 v30, v238
    v_mov_b32 v31, v239
Ld_65:
    s_mov_b32 s67, 0x07060302
    v_perm_b32 v20, v25, v24, s67
    v_perm_b32 v21, v27, v26, s67
    v_perm_b32 v22, v29, v28, s67
    v_perm_b32 v23, v31, v30, s67
    v_mov_b32 v9, 159944
    s_mov_b32 s70, 0
Lh_69:
    ds_read_b32 v10, v9
    s_add_u32 s70, s70, 1
    s_cmp_gt_u32 s70, 0x4000
    s_cbranch_scc1 L_fail
    s_waitcnt lgkmcnt(0)
    v_cmp_gt_u32 vcc, 4, v10
    s_cbranch_vccnz Lh_69
    v_add_u32 v9, 160768, v122
    ds_write_b128 v9, v[20:23]
    v_mov_b32 v9, 160064
    v_mov_b32 v20, s71
    v_mov_b32 v21, s65
    ds_write_b64 v9, v[20:21]
    v_mov_b32 v9, 159936
    v_mov_b32 v10, s95
    s_waitcnt lgkmcnt(0)
    ds_write_b32 v9, v10
Lj_50:
    v_mov_b32 v9, 159944
    s_mov_b32 s70, 0
Lh_70:
    ds_read_b32 v10, v9
    s_add_u32 s70, s70, 1
    s_cmp_gt_u32 s70, 0x4000
    s_cbranch_scc1 L_fail
    s_waitcnt lgkmcnt(0)
    v_cmp_gt_u32 vcc, 4, v10
    s_cbranch_vccnz Lh_70
    v_mov_b32 v9, 159952
    s_mov_b32 s70, 0
Lh_71:
    s_sleep 1
    ds_read_b128 v[16:19], v9
    s_add_u32 s70, s70, 1
    s_cmp_gt_u32 s70, 0x4000
    s_cbranch_scc1 L_fail
    s_waitcnt lgkmcnt(0)
    v_xor_b32 v17, v16, v17
    v_bitop3_b32 v17, v17, v16, v18 bitop3:0xf6
    v_bitop3_b32 v17, v17, v16, v19 bitop3:0xf6
    v_xor_b32 v16, s95, v16
    v_or_b32 v16, v16, v17
    v_cmp_ne_u32 vcc, 0, v16
    s_cbranch_vccnz Lh_71
    s_mov_b32 s32, s12
    s_mov_b32 s33, s13
    s_mov_b32 s34, 4194304
    s_mov_b32 s35, 0x20000
    s_lshl_b32 s66, s60, 19
    s_lshl_b32 s67, s61, 14
    s_add_u32 s66, s66, s67
    s_add_u32 s66, s66, s69
    s_add_u32 m0, s69, 131072
    s_add_u32 s67, s66, 0
    buffer_load_dwordx4 v122, s[32:35], s67 offen nt lds
    s_add_u32 m0, s69, 132096
    s_add_u32 s67, s66, 1024
    buffer_load_dwordx4 v122, s[32:35], s67 offen nt lds
    s_add_u32 m0, s69, 133120
    s_add_u32 s67, s66, 2048
    buffer_load_dwordx4 v122, s[32:35], s67 offen nt lds
    s_add_u32 m0, s69, 134144
    s_add_u32 s67, s66, 3072
    buffer_load_dwordx4 v122, s[32:35], s67 offen nt lds
    v_mov_b32 v113, 0
    s_add_u32 s66, s69, 131072
    v_add_u32 v11, s66, v122
    v_lshlrev_b32 v10, 2, v12
    s_lshl_b32 s66, s63, 4
    s_add_u32 s66, s66, 160192
    v_add_u32 v10, s66, v10
    s_cmp_lg_u32 s63, 0
    s_cbranch_scc1 Lk_72
    s_mul_i32 s66, s61, 2560
    s_add_u32 s66, s66, s75
    buffer_load_dwordx4 v[124:127], v122, s[28:31], s66 offen offset:0 nt
    buffer_load_dwordx4 v[124:127], v122, s[28:31], s66 offen offset:1024 nt
    buffer_load_dwordx4 v[124:127], v122, s[28:31], s66 offen offset:1536 nt
    s_waitcnt vmcnt(3)
    s_branch Lk_75
Lk_72:
    s_cmp_lg_u32 s63, 1
    s_cbranch_scc1 Lk_73
    s_lshl_b32 s66, s61, 7
    s_add_u32 s67, s66, s76
    v_mov_b32 v9, s67
    s_min_u32 s67, s62, 2
    s_lshl_b32 s67, s67, 13
    s_and_b32 s66, s66, 0x380
    s_add_u32 s67, s67, s66
    s_add_u32 s67, s67, s77
    v_writelane_b32 v9, s67, 1
    s_mov_b64 exec, 3
    buffer_load_dword v124, v9, s[28:31], 0 offen
    s_mov_b64 exec, -1
    s_waitcnt vmcnt(1)
    s_branch Lk_75
Lk_73:
    s_cmp_lg_u32 s63, 3
    s_cbranch_scc1 Lk_74
    s_cmp_ge_u32 s61, 28
    s_cbranch_scc1 Lk_74
    s_mul_i32 s66, s60, 229376
    s_lshl_b32 s67, s61, 13
    s_add_u32 s66, s66, s67
    s_mov_b32 m0, 147456
    s_add_u32 s67, s66, 0
    buffer_load_dwordx4 v122, s[44:47], s67 offen nt lds
    s_mov_b32 m0, 148480
    s_add_u32 s67, s66, 1024
    buffer_load_dwordx4 v122, s[44:47], s67 offen nt lds
    s_mov_b32 m0, 149504
    s_add_u32 s67, s66, 2048
    buffer_load_dwordx4 v122, s[44:47], s67 offen nt lds
    s_mov_b32 m0, 150528
    s_add_u32 s67, s66, 3072
    buffer_load_dwordx4 v122, s[44:47], s67 offen nt lds
    s_mov_b32 m0, 151552
    s_add_u32 s67, s66, 4096
    buffer_load_dwordx4 v122, s[44:47], s67 offen nt lds
    s_mov_b32 m0, 152576
    s_add_u32 s67, s66, 5120
    buffer_load_dwordx4 v122, s[44:47], s67 offen nt lds
    s_mov_b32 m0, 153600
    s_add_u32 s67, s66, 6144
    buffer_load_dwordx4 v122, s[44:47], s67 offen nt lds
    s_mov_b32 m0, 154624
    s_add_u32 s67, s66, 7168
    buffer_load_dwordx4 v122, s[44:47], s67 offen nt lds
    s_waitcnt vmcnt(8)
    s_branch Lk_75
Lk_74:
    s_waitcnt vmcnt(0)
Lk_75:
    ds_read_b128 v[48:51], v11 offset:0
    ds_read_b128 v[52:55], v11 offset:1024
    ds_read_b128 v[56:59], v11 offset:2048
    ds_read_b128 v[60:63], v11 offset:3072
    v_mov_b32 v47, 0x3f803f80
    s_waitcnt lgkmcnt(3)
    v_dot2_f32_bf16 v64, v48, v47, 0
    s_waitcnt lgkmcnt(2)
    v_dot2_f32_bf16 v65, v52, v47, 0
    s_waitcnt lgkmcnt(1)
    v_dot2_f32_bf16 v66, v56, v47, 0
    s_waitcnt lgkmcnt(0)
    v_dot2_f32_bf16 v67, v60, v47, 0
    v_dot2_f32_bf16 v64, v49, v47, v64
    v_dot2_f32_bf16 v65, v53, v47, v65
    v_dot2_f32_bf16 v66, v57, v47, v66
    v_dot2_f32_bf16 v67, v61, v47, v67
    v_dot2_f32_bf16 v64, v50, v47, v64
    v_dot2_f32_bf16 v65, v54, v47, v65
    v_dot2_f32_bf16 v66, v58, v47, v66
    v_dot2_f32_bf16 v67, v62, v47, v67
    v_dot2_f32_bf16 v64, v51, v47, v64
    v_dot2_f32_bf16 v65, v55, v47, v65
    v_dot2_f32_bf16 v66, v59, v47, v66
    v_dot2_f32_bf16 v67, v63, v47, v67
    s_nop 1
    v_permlane32_swap_b32 v64, v66
    v_permlane32_swap_b32 v65, v67
    v_pk_add_f32 v[64:65], v[64:65], v[66:67]
    s_nop 1
    v_permlane16_swap_b32 v64, v65
    v_add_f32 v64, v64, v65
    s_nop 1
    v_add_f32_dpp v64, v64, v64 row_ror:4 row_mask:0xf bank_mask:0xf
    s_nop 1
    v_add_f32_dpp v64, v64, v64 row_ror:8 row_mask:0xf bank_mask:0xf
    s_nop 1
    v_add_f32_dpp v64, v64, v64 quad_perm:[1,0,3,2] row_mask:0xf bank_mask:0xf
    s_nop 1
    v_add_f32_dpp v64, v64, v64 quad_perm:[2,3,0,1] row_mask:0xf bank_mask:0xf
    v_mul_f32 v64, 0x3b000000, v64
    ds_write_b32 v10, v64
    s_waitcnt lgkmcnt(0)
    s_bfe_u32 s66, s95, 0xc0008
    s_or_b32 s66, s66, 0x80
    v_mov_b32 v118, s66
    v_mov_b32 v120, 0x1
    s_barrier
    ds_read_b64_tr_b16 v[160:161], v111 offset:0
    ds_read_b64_tr_b16 v[162:163], v111 offset:4096
    ds_read_b64_tr_b16 v[164:165], v111 offset:8192
    ds_read_b64_tr_b16 v[166:167], v111 offset:12288
    ds_read_b64_tr_b16 v[168:169], v111 offset:8
    ds_read_b64_tr_b16 v[170:171], v111 offset:4104
    ds_read_b64_tr_b16 v[172:173], v111 offset:8200
    ds_read_b64_tr_b16 v[174:175], v111 offset:12296
    v_lshlrev_b32 v9, 4, v12
    v_add_u32 v9, 160192, v9
    ds_read_b128 v[96:99], v9
    s_mov_b32 s70, 0
Lp_76:
    buffer_load_dwordx4 v[24:27], v109, s[28:31], s75 offen offset:256 nt
    buffer_load_dwordx4 v[28:31], v109, s[28:31], s75 offen offset:1536 nt
    buffer_load_dwordx4 v[16:19], v108, s[28:31], s75 offen offset:0 nt
    buffer_load_dwordx4 v[20:23], v108, s[28:31], s75 offen offset:1280 nt
    s_add_u32 s70, s70, 1
    s_cmp_gt_u32 s70, 0x2000
    s_cbranch_scc1 L_fail
    s_waitcnt vmcnt(0)
    v_xor_b32 v119, v16, v118
    v_bitop3_b32 v119, v119, v17, v118 bitop3:0xf6
    v_bitop3_b32 v119, v119, v18, v118 bitop3:0xf6
    v_bitop3_b32 v119, v119, v19, v118 bitop3:0xf6
    v_bitop3_b32 v119, v119, v20, v118 bitop3:0xf6
    v_bitop3_b32 v119, v119, v21, v118 bitop3:0xf6
    v_bitop3_b32 v119, v119, v22, v118 bitop3:0xf6
    v_bitop3_b32 v119, v119, v23, v118 bitop3:0xf6
    v_bitop3_b32 v119, v119, v25, v118 bitop3:0xf6
    v_bitop3_b32 v119, v119, v26, v118 bitop3:0xf6
    v_bitop3_b32 v119, v119, v27, v118 bitop3:0xf6
    v_bitop3_b32 v119, v119, v29, v118 bitop3:0xf6
    v_bitop3_b32 v119, v119, v30, v118 bitop3:0xf6
    v_bitop3_b32 v119, v119, v31, v118 bitop3:0xf6
    v_and_b32 v119, 0xfff, v119
    v_cmp_ne_u32 vcc, 0, v119
    s_cbranch_vccnz Lp_76
    v_max_f32 v26, v24, v28
    s_nop 1
    v_max_f32_dpp v26, v26, v26 row_ror:4 row_mask:0xf bank_mask:0xf
    s_nop 1
    v_max_f32_dpp v26, v26, v26 row_ror:8 row_mask:0xf bank_mask:0xf
    v_sub_f32 v24, v24, v26
    v_sub_f32 v28, v28, v26
    v_exp_f32 v24, v24
    v_exp_f32 v28, v28
    v_pk_mul_f32 v[16:17], v[16:17], v[24:25] op_sel_hi:[1,0]
    v_pk_mul_f32 v[18:19], v[18:19], v[24:25] op_sel_hi:[1,0]
    v_add_f32 v26, v24, v28
    v_pk_fma_f32 v[16:17], v[20:21], v[28:29], v[16:17] op_sel_hi:[1,0,1]
    v_pk_fma_f32 v[18:19], v[22:23], v[28:29], v[18:19] op_sel_hi:[1,0,1]
    v_add_f32_dpp v26, v26, v26 row_ror:4 row_mask:0xf bank_mask:0xf
    v_add_f32_dpp v16, v16, v16 row_ror:4 row_mask:0xf bank_mask:0xf
    v_add_f32_dpp v17, v17, v17 row_ror:4 row_mask:0xf bank_mask:0xf
    v_add_f32_dpp v18, v18, v18 row_ror:4 row_mask:0xf bank_mask:0xf
    v_add_f32_dpp v19, v19, v19 row_ror:4 row_mask:0xf bank_mask:0xf
    v_add_f32_dpp v26, v26, v26 row_ror:8 row_mask:0xf bank_mask:0xf
    v_add_f32_dpp v16, v16, v16 row_ror:8 row_mask:0xf bank_mask:0xf
    v_add_f32_dpp v17, v17, v17 row_ror:8 row_mask:0xf bank_mask:0xf
    v_add_f32_dpp v18, v18, v18 row_ror:8 row_mask:0xf bank_mask:0xf
    v_add_f32_dpp v19, v19, v19 row_ror:8 row_mask:0xf bank_mask:0xf
    v_rcp_f32 v26, v26
    s_nop 0
    v_pk_mul_f32 v[16:17], v[16:17], v[26:27] op_sel_hi:[1,0]
    v_pk_mul_f32 v[18:19], v[18:19], v[26:27] op_sel_hi:[1,0]
    v_cvt_pk_bf16_f32 v212, v16, v17
    v_cvt_pk_bf16_f32 v213, v18, v19
    s_waitcnt lgkmcnt(0)
    s_nop 0
    v_mfma_f32_4x4x4_16b_bf16 v[216:219], v[160:161], v[212:213], 0 blgp:4
    v_mul_f32 v26, v16, v96
    v_mfma_f32_4x4x4_16b_bf16 v[220:223], v[168:169], v[212:213], 0 blgp:4
    v_fmac_f32 v26, v17, v97
    v_mfma_f32_4x4x4_16b_bf16 v[216:219], v[162:163], v[212:213], v[216:219] blgp:5
    v_fmac_f32 v26, v18, v98
    v_mfma_f32_4x4x4_16b_bf16 v[220:223], v[170:171], v[212:213], v[220:223] blgp:5
    v_fmac_f32 v26, v19, v99
    v_mfma_f32_4x4x4_16b_bf16 v[216:219], v[164:165], v[212:213], v[216:219] blgp:6
    v_mov_b32 v27, v26
    v_mfma_f32_4x4x4_16b_bf16 v[220:223], v[172:173], v[212:213], v[220:223] blgp:6
    s_nop 0
    v_permlane16_swap_b32 v26, v27
    v_mfma_f32_4x4x4_16b_bf16 v[216:219], v[166:167], v[212:213], v[216:219] blgp:7
    v_add_f32 v26, v26, v27
    v_mfma_f32_4x4x4_16b_bf16 v[220:223], v[174:175], v[212:213], v[220:223] blgp:7
    v_mov_b32 v27, v26
    s_nop 1
    v_permlane32_swap_b32 v26, v27
    v_add_f32 v26, v26, v27
    v_pk_add_f32 v[216:217], v[216:217], v[26:27] op_sel_hi:[1,0] neg_lo:[0,1] neg_hi:[0,1]
    v_pk_add_f32 v[218:219], v[218:219], v[26:27] op_sel_hi:[1,0] neg_lo:[0,1] neg_hi:[0,1]
    v_pk_add_f32 v[220:221], v[220:221], v[26:27] op_sel_hi:[1,0] neg_lo:[0,1] neg_hi:[0,1]
    v_pk_add_f32 v[222:223], v[222:223], v[26:27] op_sel_hi:[1,0] neg_lo:[0,1] neg_hi:[0,1]
    v_cvt_pk_bf16_f32 v248, v216, v217
    v_cvt_pk_bf16_f32 v249, v218, v219
    v_cvt_pk_bf16_f32 v250, v220, v221
    v_cvt_pk_bf16_f32 v251, v222, v223
    v_and_or_b32 v248, v248, s74, v120
    s_cmp_eq_u32 s65, 0
    s_cbranch_scc1 Ls_77
    buffer_store_dwordx4 v[248:251], v106, s[28:31], s72 offen
Lb_78:
    s_barrier
    v_mov_b32 v114, v26
    v_mov_b32 v9, 160072
    ds_read_b32 v10, v9
    s_waitcnt lgkmcnt(0)
    v_lshrrev_b32 v10, s60, v10
    v_and_b32 v10, 1, v10
    v_lshl_add_u32 v107, v10, 13, v107
    s_cmp_lg_u32 s63, 2
    s_cbranch_scc1 Lk_79
    v_lshlrev_b32 v9, 2, v13
    v_lshl_add_u32 v9, v12, 7, v9
    v_add_u32 v9, 159808, v9
    v_mov_b32 v10, 0
    s_mov_b32 exec_hi, 0
    ds_write_b32 v9, v10
    s_mov_b64 exec, -1
Lk_79:
    s_cmp_lg_u32 s63, 3
    s_cbranch_scc1 Lk_80
    ds_read_b64_tr_b16 v[176:177], v104 offset:0
    ds_read_b64_tr_b16 v[178:179], v104 offset:4096
    ds_read_b64_tr_b16 v[180:181], v104 offset:8
    ds_read_b64_tr_b16 v[182:183], v104 offset:4104
    ds_read_b64_tr_b16 v[184:185], v104 offset:256
    ds_read_b64_tr_b16 v[186:187], v104 offset:4352
    ds_read_b64_tr_b16 v[188:189], v104 offset:264
    ds_read_b64_tr_b16 v[190:191], v104 offset:4360
    ds_read_b64_tr_b16 v[192:193], v104 offset:512
    ds_read_b64_tr_b16 v[194:195], v104 offset:4608
    ds_read_b64_tr_b16 v[196:197], v104 offset:520
    ds_read_b64_tr_b16 v[198:199], v104 offset:4616
    ds_read_b64_tr_b16 v[200:201], v104 offset:768
    ds_read_b64_tr_b16 v[202:203], v104 offset:4864
    ds_read_b64_tr_b16 v[204:205], v104 offset:776
    ds_read_b64_tr_b16 v[206:207], v104 offset:4872
    v_add_u32 v9, 147456, v122
    ds_read_b128 v[48:51], v9 offset:0
    ds_read_b128 v[52:55], v9 offset:1024
    ds_read_b128 v[56:59], v9 offset:2048
    ds_read_b128 v[60:63], v9 offset:3072
    v_mov_b32 v47, 0x3f803f80
    s_waitcnt lgkmcnt(3)
    v_dot2_f32_bf16 v64, v48, v47, 0
    s_waitcnt lgkmcnt(2)
    v_dot2_f32_bf16 v65, v52, v47, 0
    s_waitcnt lgkmcnt(1)
    v_dot2_f32_bf16 v66, v56, v47, 0
    s_waitcnt lgkmcnt(0)
    v_dot2_f32_bf16 v67, v60, v47, 0
    v_dot2_f32_bf16 v64, v49, v47, v64
    v_dot2_f32_bf16 v65, v53, v47, v65
    v_dot2_f32_bf16 v66, v57, v47, v66
    v_dot2_f32_bf16 v67, v61, v47, v67
    v_dot2_f32_bf16 v64, v50, v47, v64
    v_dot2_f32_bf16 v65, v54, v47, v65
    v_dot2_f32_bf16 v66, v58, v47, v66
    v_dot2_f32_bf16 v67, v62, v47, v67
    v_dot2_f32_bf16 v64, v51, v47, v64
    v_dot2_f32_bf16 v65, v55, v47, v65
    v_dot2_f32_bf16 v66, v59, v47, v66
    v_dot2_f32_bf16 v67, v63, v47, v67
    s_nop 1
    v_permlane32_swap_b32 v64, v66
    v_permlane32_swap_b32 v65, v67
    v_pk_add_f32 v[64:65], v[64:65], v[66:67]
    s_nop 1
    v_permlane16_swap_b32 v64, v65
    v_add_f32 v64, v64, v65
    s_nop 1
    v_add_f32_dpp v64, v64, v64 row_ror:4 row_mask:0xf bank_mask:0xf
    s_nop 1
    v_add_f32_dpp v64, v64, v64 row_ror:8 row_mask:0xf bank_mask:0xf
    s_nop 1
    v_add_f32_dpp v64, v64, v64 quad_perm:[1,0,3,2] row_mask:0xf bank_mask:0xf
    s_nop 1
    v_add_f32_dpp v64, v64, v64 quad_perm:[2,3,0,1] row_mask:0xf bank_mask:0xf
    v_mul_f32 v64, 0x3b000000, v64
    ds_read_b128 v[48:51], v9 offset:4096
    ds_read_b128 v[52:55], v9 offset:5120
    ds_read_b128 v[56:59], v9 offset:6144
    ds_read_b128 v[60:63], v9 offset:7168
    v_mov_b32 v47, 0x3f803f80
    s_waitcnt lgkmcnt(3)
    v_dot2_f32_bf16 v68, v48, v47, 0
    s_waitcnt lgkmcnt(2)
    v_dot2_f32_bf16 v69, v52, v47, 0
    s_waitcnt lgkmcnt(1)
    v_dot2_f32_bf16 v70, v56, v47, 0
    s_waitcnt lgkmcnt(0)
    v_dot2_f32_bf16 v71, v60, v47, 0
    v_dot2_f32_bf16 v68, v49, v47, v68
    v_dot2_f32_bf16 v69, v53, v47, v69
    v_dot2_f32_bf16 v70, v57, v47, v70
    v_dot2_f32_bf16 v71, v61, v47, v71
    v_dot2_f32_bf16 v68, v50, v47, v68
    v_dot2_f32_bf16 v69, v54, v47, v69
    v_dot2_f32_bf16 v70, v58, v47, v70
    v_dot2_f32_bf16 v71, v62, v47, v71
    v_dot2_f32_bf16 v68, v51, v47, v68
    v_dot2_f32_bf16 v69, v55, v47, v69
    v_dot2_f32_bf16 v70, v59, v47, v70
    v_dot2_f32_bf16 v71, v63, v47, v71
    s_nop 1
    v_permlane32_swap_b32 v68, v70
    v_permlane32_swap_b32 v69, v71
    v_pk_add_f32 v[68:69], v[68:69], v[70:71]
    s_nop 1
    v_permlane16_swap_b32 v68, v69
    v_add_f32 v68, v68, v69
    s_nop 1
    v_add_f32_dpp v68, v68, v68 row_ror:4 row_mask:0xf bank_mask:0xf
    s_nop 1
    v_add_f32_dpp v68, v68, v68 row_ror:8 row_mask:0xf bank_mask:0xf
    s_nop 1
    v_add_f32_dpp v68, v68, v68 quad_perm:[1,0,3,2] row_mask:0xf bank_mask:0xf
    s_nop 1
    v_add_f32_dpp v68, v68, v68 quad_perm:[2,3,0,1] row_mask:0xf bank_mask:0xf
    v_mul_f32 v68, 0x3b000000, v68
    v_lshlrev_b32 v9, 2, v12
    v_add_u32 v9, 147456, v9
    ds_write2_b32 v9, v64, v68 offset0:0 offset1:4
    v_and_b32 v9, 1, v12
    v_lshlrev_b32 v9, 4, v9
    v_add_u32 v9, 147456, v9
    s_waitcnt lgkmcnt(0)
    ds_read_b128 v[92:95], v9
    s_waitcnt lgkmcnt(0)
Lk_80:
    s_add_u32 s66, s64, 1
    s_and_b32 s66, s66, 0x7f
    v_mov_b32 v118, s66
    v_mov_b32 v120, 0x10000
    s_barrier
    s_mov_b32 s70, 0
    s_sleep 8
Lp_81:
    buffer_load_dwordx4 v[16:19], v107, s[28:31], s80 offen offset:0 sc1
    buffer_load_dwordx4 v[20:23], v107, s[28:31], s80 offen offset:1024 sc1
    s_add_u32 s70, s70, 1
    s_cmp_gt_u32 s70, 0x2000
    s_cbranch_scc1 L_fail
    s_waitcnt vmcnt(0)
    v_xor_b32 v119, v16, v118
    v_bitop3_b32 v119, v119, v18, v123 bitop3:0xf6
    v_bitop3_b32 v119, v119, v20, v118 bitop3:0xf6
    v_bitop3_b32 v119, v119, v22, v123 bitop3:0xf6
    v_and_b32 v119, 0xff, v119
    v_cmp_ne_u32 vcc, 0, v119
    s_cbranch_vccnz Lp_81
    v_pk_add_f32 v[16:17], v[16:17], v[20:21]
    v_pk_add_f32 v[18:19], v[18:19], v[22:23]
    s_nop 0
    v_add_f32_dpp v16, v16, v16 row_ror:4 row_mask:0xf bank_mask:0xf
    v_add_f32_dpp v17, v17, v17 row_ror:4 row_mask:0xf bank_mask:0xf
    v_add_f32_dpp v18, v18, v18 row_ror:4 row_mask:0xf bank_mask:0xf
    v_add_f32_dpp v19, v19, v19 row_ror:4 row_mask:0xf bank_mask:0xf
    v_add_f32_dpp v16, v16, v16 row_ror:8 row_mask:0xf bank_mask:0xf
    v_add_f32_dpp v17, v17, v17 row_ror:8 row_mask:0xf bank_mask:0xf
    v_add_f32_dpp v18, v18, v18 row_ror:8 row_mask:0xf bank_mask:0xf
    v_add_f32_dpp v19, v19, v19 row_ror:8 row_mask:0xf bank_mask:0xf
    v_pk_add_f32 v[208:209], v[16:17], v[208:209]
    v_pk_add_f32 v[210:211], v[18:19], v[210:211]
    v_cvt_pk_bf16_f32 v212, v208, v209
    v_cvt_pk_bf16_f32 v213, v210, v211
    s_nop 1
    v_mfma_f32_4x4x4_16b_bf16 v[216:219], v[144:145], v[212:213], 0 blgp:4
    v_mfma_f32_4x4x4_16b_bf16 v[220:223], v[152:153], v[212:213], 0 blgp:4
    s_nop 0
    v_mfma_f32_4x4x4_16b_bf16 v[216:219], v[146:147], v[212:213], v[216:219] blgp:5
    v_mfma_f32_4x4x4_16b_bf16 v[220:223], v[154:155], v[212:213], v[220:223] blgp:5
    s_nop 0
    v_mfma_f32_4x4x4_16b_bf16 v[216:219], v[148:149], v[212:213], v[216:219] blgp:6
    v_mfma_f32_4x4x4_16b_bf16 v[220:223], v[156:157], v[212:213], v[220:223] blgp:6
    s_nop 0
    v_mfma_f32_4x4x4_16b_bf16 v[216:219], v[150:151], v[212:213], v[216:219] blgp:7
    v_mfma_f32_4x4x4_16b_bf16 v[220:223], v[158:159], v[212:213], v[220:223] blgp:7
    s_nop 3
    v_cvt_pk_bf16_f32 v248, v216, v217
    v_cvt_pk_bf16_f32 v249, v218, v219
    v_cvt_pk_bf16_f32 v250, v220, v221
    v_cvt_pk_bf16_f32 v251, v222, v223
    v_and_or_b32 v248, v248, s74, v120
    s_mov_b64 exec, s[86:87]
    s_cmp_eq_u32 s65, 0
    s_cbranch_scc1 Ls_82
    buffer_store_dwordx4 v[248:251], v105, s[28:31], s72 offen
Lb_83:
    s_mov_b64 exec, -1
    s_cmp_lg_u32 s63, 3
    s_cbranch_scc1 Lw_84
    s_cmp_lt_u32 s61, 28
    s_cbranch_scc1 Lk_86
    s_branch Lj_85
Lk_86:
    v_mov_b32 v118, 0x10001
    s_mov_b32 s70, 0
    s_sleep 3
    s_nop 7
Lp_87:
    buffer_load_dwordx4 v[16:19], v116, s[28:31], s72 offen offset:0 nt
    buffer_load_dwordx4 v[20:23], v116, s[28:31], s72 offen offset:1024 nt
    buffer_load_dwordx4 v[24:27], v116, s[28:31], s72 offen offset:2048 nt
    buffer_load_dwordx4 v[28:31], v116, s[28:31], s72 offen offset:3072 nt
    s_add_u32 s70, s70, 1
    s_cmp_gt_u32 s70, 0x2000
    s_cbranch_scc1 L_fail
    s_waitcnt vmcnt(0)
    v_xor_b32 v119, v16, v120
    v_bitop3_b32 v119, v119, v20, v120 bitop3:0xf6
    v_bitop3_b32 v119, v119, v24, v120 bitop3:0xf6
    v_bitop3_b32 v119, v119, v28, v120 bitop3:0xf6
    v_and_b32 v119, 0x10001, v119
    v_cmp_ne_u32 vcc, 0, v119
    s_cbranch_vccnz Lp_87
    v_mfma_f32_16x16x32_bf16 v[32:35], v[88:91], v[16:19], 0
    v_mfma_f32_16x16x32_bf16 v[32:35], v[88:91], v[20:23], v[32:35]
    v_mfma_f32_16x16x32_bf16 v[32:35], v[88:91], v[24:27], v[32:35]
    v_mfma_f32_16x16x32_bf16 v[32:35], v[88:91], v[28:31], v[32:35]
    s_nop 7
    v_add_f32_dpp v32, v32, v32 row_ror:8 row_mask:0xf bank_mask:0xf
    v_add_f32_dpp v33, v33, v33 row_ror:8 row_mask:0xf bank_mask:0xf
    v_add_f32_dpp v34, v34, v34 row_ror:8 row_mask:0xf bank_mask:0xf
    v_add_f32_dpp v35, v35, v35 row_ror:8 row_mask:0xf bank_mask:0xf
    v_max_f32 v36, 0, v32
    v_max_f32 v37, 0, v33
    v_max_f32 v38, 0, v34
    v_max_f32 v39, 0, v35
    v_mul_f32_dpp v36, v32, v36 row_shl:4 row_mask:0xf bank_mask:0xf
    v_mul_f32_dpp v37, v33, v37 row_shl:4 row_mask:0xf bank_mask:0xf
    v_mul_f32_dpp v38, v34, v38 row_shl:4 row_mask:0xf bank_mask:0xf
    v_mul_f32_dpp v39, v35, v39 row_shl:4 row_mask:0xf bank_mask:0xf
    v_cvt_pk_bf16_f32 v20, v36, v37
    v_cvt_pk_bf16_f32 v21, v38, v39
    v_mul_f32_e64 v24, v36, -v92
    v_fma_f32 v24, v37, -v93, v24
    v_fma_f32 v24, v38, -v94, v24
    v_fma_f32 v24, v39, -v95, v24
    v_mov_b32_dpp v20, v20 row_shr:4 row_mask:0xf bank_mask:0xa
    v_mov_b32_dpp v21, v21 row_shr:4 row_mask:0xf bank_mask:0xa
    v_mov_b32 v25, v24
    s_nop 1
    v_permlane16_swap_b32 v24, v25
    v_add_f32 v24, v24, v25
    s_nop 1
    v_mov_b32_dpp v24, v24 row_shr:4 row_mask:0xf bank_mask:0xa
    v_mov_b32 v25, v24
    v_mov_b32 v26, v24
    v_mov_b32 v27, v24
    s_nop 1
    v_mfma_f32_4x4x4_16b_bf16 v[216:219], v[176:177], v[20:21], v[24:27] blgp:4
    v_mfma_f32_4x4x4_16b_bf16 v[220:223], v[180:181], v[20:21], v[24:27] blgp:4
    v_mfma_f32_4x4x4_16b_bf16 v[224:227], v[184:185], v[20:21], v[24:27] blgp:4
    v_mfma_f32_4x4x4_16b_bf16 v[228:231], v[188:189], v[20:21], v[24:27] blgp:4
    v_mfma_f32_4x4x4_16b_bf16 v[232:235], v[192:193], v[20:21], v[24:27] blgp:4
    v_mfma_f32_4x4x4_16b_bf16 v[236:239], v[196:197], v[20:21], v[24:27] blgp:4
    v_mfma_f32_4x4x4_16b_bf16 v[240:243], v[200:201], v[20:21], v[24:27] blgp:4
    v_mfma_f32_4x4x4_16b_bf16 v[244:247], v[204:205], v[20:21], v[24:27] blgp:4
    v_mfma_f32_4x4x4_16b_bf16 v[216:219], v[178:179], v[20:21], v[216:219] blgp:5
    v_mfma_f32_4x4x4_16b_bf16 v[220:223], v[182:183], v[20:21], v[220:223] blgp:5
    v_mfma_f32_4x4x4_16b_bf16 v[224:227], v[186:187], v[20:21], v[224:227] blgp:5
    v_mfma_f32_4x4x4_16b_bf16 v[228:231], v[190:191], v[20:21], v[228:231] blgp:5
    v_mfma_f32_4x4x4_16b_bf16 v[232:235], v[194:195], v[20:21], v[232:235] blgp:5
    v_mfma_f32_4x4x4_16b_bf16 v[236:239], v[198:199], v[20:21], v[236:239] blgp:5
    v_mfma_f32_4x4x4_16b_bf16 v[240:243], v[202:203], v[20:21], v[240:243] blgp:5
    v_mfma_f32_4x4x4_16b_bf16 v[244:247], v[206:207], v[20:21], v[244:247] blgp:5
    s_cmp_eq_u32 s65, 0
    v_cvt_pk_bf16_f32 v32, v216, v217
    v_cvt_pk_bf16_f32 v33, v218, v219
    v_cvt_pk_bf16_f32 v34, v220, v221
    v_cvt_pk_bf16_f32 v35, v222, v223
    v_and_or_b32 v32, v32, s74, v118
    buffer_store_dwordx4 v[32:35], v116, s[28:31], s72 offen offset:0
    v_cvt_pk_bf16_f32 v36, v224, v225
    v_cvt_pk_bf16_f32 v37, v226, v227
    v_cvt_pk_bf16_f32 v38, v228, v229
    v_cvt_pk_bf16_f32 v39, v230, v231
    v_and_or_b32 v36, v36, s74, v118
    buffer_store_dwordx4 v[36:39], v116, s[28:31], s72 offen offset:1024
    v_cvt_pk_bf16_f32 v40, v232, v233
    v_cvt_pk_bf16_f32 v41, v234, v235
    v_cvt_pk_bf16_f32 v42, v236, v237
    v_cvt_pk_bf16_f32 v43, v238, v239
    v_and_or_b32 v40, v40, s74, v118
    buffer_store_dwordx4 v[40:43], v116, s[28:31], s72 offen offset:2048
    v_cvt_pk_bf16_f32 v44, v240, v241
    v_cvt_pk_bf16_f32 v45, v242, v243
    v_cvt_pk_bf16_f32 v46, v244, v245
    v_cvt_pk_bf16_f32 v47, v246, v247
    v_and_or_b32 v44, v44, s74, v118
    buffer_store_dwordx4 v[44:47], v116, s[28:31], s72 offen offset:3072
    s_cbranch_scc1 Ls_88
Lb_89:
    v_mov_b32 v113, v24
    s_branch Lj_85
Lw_84:
    s_cmp_lg_u32 s63, 2
    s_cbranch_scc1 Lk_90
    v_mul_f32 v30, v208, v208
    v_fmac_f32 v30, v209, v209
    v_fmac_f32 v30, v210, v210
    v_fmac_f32 v30, v211, v211
    v_mov_b32 v31, v30
    s_nop 1
    v_permlane16_swap_b32 v30, v31
    v_add_f32 v30, v30, v31
    v_mov_b32 v31, v30
    s_nop 1
    v_permlane32_swap_b32 v30, v31
    v_add_f32 v30, v30, v31
    s_bfe_u32 s66, s95, 0xc0008
    s_or_b32 s66, s66, 0x80
    v_mov_b32 v31, s66
    v_and_or_b32 v30, v30, s94, v31
    s_add_u32 s68, s77, 0
    s_mov_b64 exec, 15
    s_cmp_eq_u32 s65, 0
    s_cbranch_scc1 Ls_91
    buffer_store_dword v30, v110, s[28:31], s68 offen offset:0
Lb_92:
    s_mov_b64 exec, -1
Lk_90:
    s_cmp_lg_u32 s63, 1
    s_cbranch_scc1 Lk_93
    s_add_u32 s68, s77, 0
    s_bfe_u32 s66, s95, 0xc0008
    s_or_b32 s66, s66, 0x80
    v_mov_b32 v28, s66
    s_mov_b32 exec_hi, 0
    s_mov_b32 s70, 0
    s_sleep 5
    s_branch Lg_95
Lp_94:
    s_sleep 1
Lg_95:
    buffer_load_dwordx4 v[24:27], v122, s[28:31], s68 offen nt
    s_add_u32 s70, s70, 1
    s_cmp_gt_u32 s70, 0x2000
    s_cbranch_scc1 L_fail
    s_waitcnt vmcnt(0)
    v_xor_b32 v119, v24, v28
    v_bitop3_b32 v119, v119, v25, v28 bitop3:0xf6
    v_bitop3_b32 v119, v119, v26, v28 bitop3:0xf6
    v_bitop3_b32 v119, v119, v27, v28 bitop3:0xf6
    v_and_b32 v119, 0xfff, v119
    v_cmp_ne_u32 vcc, 0, v119
    s_cbranch_vccnz Lp_94
    s_mov_b64 exec, -1
    v_add_f32_dpp v24, v24, v24 quad_perm:[1,0,3,2] row_mask:0xf bank_mask:0xf
    v_add_f32_dpp v25, v25, v25 quad_perm:[1,0,3,2] row_mask:0xf bank_mask:0xf
    v_add_f32_dpp v26, v26, v26 quad_perm:[1,0,3,2] row_mask:0xf bank_mask:0xf
    v_add_f32_dpp v27, v27, v27 quad_perm:[1,0,3,2] row_mask:0xf bank_mask:0xf
    v_add_f32_dpp v24, v24, v24 quad_perm:[2,3,0,1] row_mask:0xf bank_mask:0xf
    v_add_f32_dpp v25, v25, v25 quad_perm:[2,3,0,1] row_mask:0xf bank_mask:0xf
    v_add_f32_dpp v26, v26, v26 quad_perm:[2,3,0,1] row_mask:0xf bank_mask:0xf
    v_add_f32_dpp v27, v27, v27 quad_perm:[2,3,0,1] row_mask:0xf bank_mask:0xf
    v_add_f32_dpp v24, v24, v24 row_ror:4 row_mask:0xf bank_mask:0xf
    v_add_f32_dpp v25, v25, v25 row_ror:4 row_mask:0xf bank_mask:0xf
    v_add_f32_dpp v26, v26, v26 row_ror:4 row_mask:0xf bank_mask:0xf
    v_add_f32_dpp v27, v27, v27 row_ror:4 row_mask:0xf bank_mask:0xf
    v_add_f32_dpp v24, v24, v24 row_ror:8 row_mask:0xf bank_mask:0xf
    v_add_f32_dpp v25, v25, v25 row_ror:8 row_mask:0xf bank_mask:0xf
    v_add_f32_dpp v26, v26, v26 row_ror:8 row_mask:0xf bank_mask:0xf
    v_add_f32_dpp v27, v27, v27 row_ror:8 row_mask:0xf bank_mask:0xf
    v_cmp_eq_u32 vcc, 1, v14
    s_nop 1
    v_cndmask_b32 v24, v24, v25, vcc
    v_cmp_eq_u32 vcc, 2, v14
    s_nop 1
    v_cndmask_b32 v24, v24, v26, vcc
    v_cmp_eq_u32 vcc, 3, v14
    s_nop 1
    v_cndmask_b32 v24, v24, v27, vcc
    v_mov_b32 v25, v24
    s_nop 1
    v_permlane16_swap_b32 v24, v25
    v_add_f32 v24, v24, v25
    v_mov_b32 v25, v24
    s_nop 1
    v_permlane32_swap_b32 v24, v25
    v_mov_b32 v27, 0x3b000000
    v_mov_b32 v26, 0x3727c5ac
    v_fma_f32 v24, v24, v27, v26
    v_rcp_f32 v24, v24
    v_lshlrev_b32 v26, 3, v14
    v_add_u32 v26, 160080, v26
    ds_write_b64 v26, v[24:25]
    s_waitcnt lgkmcnt(0)
Lk_93:
Lj_85:
    s_barrier
    v_lshlrev_b32 v9, 3, v14
    v_add_u32 v9, 160080, v9
    ds_read_b32 v10, v9
    s_waitcnt lgkmcnt(0)
    v_fma_f32 v114, -v113, v10, v114
    s_add_u32 s66, s64, 1
    s_and_b32 s66, s66, 0x7f
    v_mov_b32 v118, s66
    v_mov_b32 v120, 0x0
    v_mov_b32 v24, -1
    v_mov_b32 v25, 160064
    ds_write_b32 v25, v24
    s_waitcnt lgkmcnt(0)
    s_barrier
    s_mov_b32 s70, 0
    s_sleep 8
Lp_96:
    buffer_load_dwordx4 v[16:19], v107, s[28:31], s81 offen offset:0 sc1
    buffer_load_dwordx4 v[20:23], v107, s[28:31], s81 offen offset:1024 sc1
    s_add_u32 s70, s70, 1
    s_cmp_gt_u32 s70, 0x2000
    s_cbranch_scc1 L_fail
    s_waitcnt vmcnt(0)
    v_xor_b32 v119, v16, v118
    v_bitop3_b32 v119, v119, v18, v123 bitop3:0xf6
    v_bitop3_b32 v119, v119, v20, v118 bitop3:0xf6
    v_bitop3_b32 v119, v119, v22, v123 bitop3:0xf6
    v_and_b32 v119, 0xff, v119
    v_cmp_ne_u32 vcc, 0, v119
    s_cbranch_vccnz Lp_96
    v_pk_add_f32 v[16:17], v[16:17], v[20:21]
    v_pk_add_f32 v[18:19], v[18:19], v[22:23]
    s_nop 0
    v_add_f32_dpp v16, v16, v16 row_ror:4 row_mask:0xf bank_mask:0xf
    v_add_f32_dpp v17, v17, v17 row_ror:4 row_mask:0xf bank_mask:0xf
    v_add_f32_dpp v18, v18, v18 row_ror:4 row_mask:0xf bank_mask:0xf
    v_add_f32_dpp v19, v19, v19 row_ror:4 row_mask:0xf bank_mask:0xf
    v_add_f32_dpp v16, v16, v16 row_ror:8 row_mask:0xf bank_mask:0xf
    v_add_f32_dpp v17, v17, v17 row_ror:8 row_mask:0xf bank_mask:0xf
    v_add_f32_dpp v18, v18, v18 row_ror:8 row_mask:0xf bank_mask:0xf
    v_add_f32_dpp v19, v19, v19 row_ror:8 row_mask:0xf bank_mask:0xf
    v_pk_add_f32 v[208:209], v[16:17], v[208:209]
    v_pk_add_f32 v[210:211], v[18:19], v[210:211]
    v_cvt_pk_bf16_f32 v212, v208, v209
    v_cvt_pk_bf16_f32 v213, v210, v211
    s_nop 1
    v_mfma_f32_4x4x4_16b_bf16 v[216:219], v[128:129], v[212:213], 0 blgp:4
    v_mfma_f32_4x4x4_16b_bf16 v[220:223], v[136:137], v[212:213], 0 blgp:4
    s_nop 0
    v_mfma_f32_4x4x4_16b_bf16 v[216:219], v[130:131], v[212:213], v[216:219] blgp:5
    v_mfma_f32_4x4x4_16b_bf16 v[220:223], v[138:139], v[212:213], v[220:223] blgp:5
    s_nop 0
    v_mfma_f32_4x4x4_16b_bf16 v[216:219], v[132:133], v[212:213], v[216:219] blgp:6
    v_mfma_f32_4x4x4_16b_bf16 v[220:223], v[140:141], v[212:213], v[220:223] blgp:6
    s_nop 0
    v_mfma_f32_4x4x4_16b_bf16 v[216:219], v[134:135], v[212:213], v[216:219] blgp:7
    v_mfma_f32_4x4x4_16b_bf16 v[220:223], v[142:143], v[212:213], v[220:223] blgp:7
    s_nop 3
    v_cvt_pk_bf16_f32 v248, v216, v217
    v_cvt_pk_bf16_f32 v249, v218, v219
    v_cvt_pk_bf16_f32 v250, v220, v221
    v_cvt_pk_bf16_f32 v251, v222, v223
    v_and_or_b32 v248, v248, s74, v120
    s_cmp_eq_u32 s65, 0
    s_cbranch_scc1 Ls_97
    buffer_store_dwordx4 v[248:251], v105, s[28:31], s72 offen
Lb_98:
    s_barrier
    s_cmp_lg_u32 s63, 2
    s_cbranch_scc1 Lk_99
    v_mul_f32 v30, v208, v208
    v_fmac_f32 v30, v209, v209
    v_fmac_f32 v30, v210, v210
    v_fmac_f32 v30, v211, v211
    v_mov_b32 v31, v30
    s_nop 1
    v_permlane16_swap_b32 v30, v31
    v_add_f32 v30, v30, v31
    v_mov_b32 v31, v30
    s_nop 1
    v_permlane32_swap_b32 v30, v31
    v_add_f32 v30, v30, v31
    s_bfe_u32 s66, s95, 0xc0008
    s_or_b32 s66, s66, 0x80
    v_mov_b32 v31, s66
    v_and_or_b32 v30, v30, s94, v31
    s_add_u32 s68, s77, 8192
    s_mov_b64 exec, 15
    s_cmp_eq_u32 s65, 0
    s_cbranch_scc1 Ls_100
    buffer_store_dword v30, v110, s[28:31], s68 offen offset:0
Lb_101:
    s_mov_b64 exec, -1
Lk_99:
    s_cmp_lg_u32 s63, 1
    s_cbranch_scc1 Lk_102
    s_add_u32 s68, s77, 8192
    s_bfe_u32 s66, s95, 0xc0008
    s_or_b32 s66, s66, 0x80
    v_mov_b32 v28, s66
    s_mov_b32 exec_hi, 0
    s_mov_b32 s70, 0
    s_sleep 5
    s_branch Lg_104
Lp_103:
    s_sleep 1
Lg_104:
    buffer_load_dwordx4 v[24:27], v122, s[28:31], s68 offen nt
    s_add_u32 s70, s70, 1
    s_cmp_gt_u32 s70, 0x2000
    s_cbranch_scc1 L_fail
    s_waitcnt vmcnt(0)
    v_xor_b32 v119, v24, v28
    v_bitop3_b32 v119, v119, v25, v28 bitop3:0xf6
    v_bitop3_b32 v119, v119, v26, v28 bitop3:0xf6
    v_bitop3_b32 v119, v119, v27, v28 bitop3:0xf6
    v_and_b32 v119, 0xfff, v119
    v_cmp_ne_u32 vcc, 0, v119
    s_cbranch_vccnz Lp_103
    s_mov_b64 exec, -1
    v_add_f32_dpp v24, v24, v24 quad_perm:[1,0,3,2] row_mask:0xf bank_mask:0xf
    v_add_f32_dpp v25, v25, v25 quad_perm:[1,0,3,2] row_mask:0xf bank_mask:0xf
    v_add_f32_dpp v26, v26, v26 quad_perm:[1,0,3,2] row_mask:0xf bank_mask:0xf
    v_add_f32_dpp v27, v27, v27 quad_perm:[1,0,3,2] row_mask:0xf bank_mask:0xf
    v_add_f32_dpp v24, v24, v24 quad_perm:[2,3,0,1] row_mask:0xf bank_mask:0xf
    v_add_f32_dpp v25, v25, v25 quad_perm:[2,3,0,1] row_mask:0xf bank_mask:0xf
    v_add_f32_dpp v26, v26, v26 quad_perm:[2,3,0,1] row_mask:0xf bank_mask:0xf
    v_add_f32_dpp v27, v27, v27 quad_perm:[2,3,0,1] row_mask:0xf bank_mask:0xf
    v_add_f32_dpp v24, v24, v24 row_ror:4 row_mask:0xf bank_mask:0xf
    v_add_f32_dpp v25, v25, v25 row_ror:4 row_mask:0xf bank_mask:0xf
    v_add_f32_dpp v26, v26, v26 row_ror:4 row_mask:0xf bank_mask:0xf
    v_add_f32_dpp v27, v27, v27 row_ror:4 row_mask:0xf bank_mask:0xf
    v_add_f32_dpp v24, v24, v24 row_ror:8 row_mask:0xf bank_mask:0xf
    v_add_f32_dpp v25, v25, v25 row_ror:8 row_mask:0xf bank_mask:0xf
    v_add_f32_dpp v26, v26, v26 row_ror:8 row_mask:0xf bank_mask:0xf
    v_add_f32_dpp v27, v27, v27 row_ror:8 row_mask:0xf bank_mask:0xf
    v_cmp_eq_u32 vcc, 1, v14
    s_nop 1
    v_cndmask_b32 v24, v24, v25, vcc
    v_cmp_eq_u32 vcc, 2, v14
    s_nop 1
    v_cndmask_b32 v24, v24, v26, vcc
    v_cmp_eq_u32 vcc, 3, v14
    s_nop 1
    v_cndmask_b32 v24, v24, v27, vcc
    v_mov_b32 v25, v24
    s_nop 1
    v_permlane16_swap_b32 v24, v25
    v_add_f32 v24, v24, v25
    v_mov_b32 v25, v24
    s_nop 1
    v_permlane32_swap_b32 v24, v25
    v_mov_b32 v27, 0x3b000000
    v_mov_b32 v26, 0x3727c5ac
    v_fma_f32 v24, v24, v27, v26
    v_rsq_f32 v24, v24
    s_nop 0
    v_mul_f32 v24, 0x3e0293ee, v24
    v_min_u32 v24, -2, v24
    s_nop 0
    v_readlane_b32 s66, v24, s62
    s_nop 1
    v_mov_b32 v24, s66
    v_mov_b32 v25, 160064
    ds_write_b32 v25, v24
    s_waitcnt lgkmcnt(0)
Lk_102:
    s_cmp_lg_u32 s63, 0
    s_cbranch_scc1 Lk_105
    v_lshlrev_b32 v9, 4, v14
    v_add_u32 v9, 160192, v9
    v_add_u32 v10, 155648, v122
    v_mov_b32 v46, 160064
    v_mov_b32 v47, 0x3f803f80
    v_lshrrev_b32 v45, 2, v1
    v_lshl_add_u32 v45, v14, 3, v45
    v_mul_u32_u24 v45, 2560, v45
    s_and_b32 s66, s61, 7
    s_mul_i32 s66, s66, 320
    s_lshl_b32 s67, s62, 4
    s_add_u32 s66, s66, s67
    v_add_u32 v45, s66, v45
    s_add_u32 s66, s64, 2
    s_and_b32 s66, s66, 0x7f
    v_mov_b32 v44, s66
    s_barrier
    ds_read_b128 v[16:19], v9
    ds_read_b32 v20, v46
    ds_read_b128 v[48:51], v10 offset:0
    ds_read_b128 v[52:55], v10 offset:1024
    ds_read_b128 v[56:59], v10 offset:2048
    ds_read_b128 v[60:63], v10 offset:3072
    s_waitcnt lgkmcnt(4)
    v_max3_f32 v21, v16, v17, v18
    v_max_f32 v21, v21, v19
    v_sub_f32 v16, v16, v21
    v_sub_f32 v17, v17, v21
    v_sub_f32 v18, v18, v21
    v_sub_f32 v19, v19, v21
    v_mul_f32 v16, v16, v20
    v_mul_f32 v17, v17, v20
    v_mul_f32 v18, v18, v20
    v_mul_f32 v19, v19, v20
    v_exp_f32 v16, v16
    v_exp_f32 v17, v17
    v_exp_f32 v18, v18
    v_exp_f32 v19, v19
    s_waitcnt lgkmcnt(0)
    v_dot2_f32_bf16 v24, v48, v47, 0
    v_dot2_f32_bf16 v25, v52, v47, 0
    v_dot2_f32_bf16 v26, v56, v47, 0
    v_dot2_f32_bf16 v27, v60, v47, 0
    v_dot2_f32_bf16 v24, v49, v47, v24
    v_dot2_f32_bf16 v25, v53, v47, v25
    v_dot2_f32_bf16 v26, v57, v47, v26
    v_dot2_f32_bf16 v27, v61, v47, v27
    v_dot2_f32_bf16 v24, v50, v47, v24
    v_dot2_f32_bf16 v25, v54, v47, v25
    v_dot2_f32_bf16 v26, v58, v47, v26
    v_dot2_f32_bf16 v27, v62, v47, v27
    v_dot2_f32_bf16 v24, v51, v47, v24
    v_dot2_f32_bf16 v25, v55, v47, v25
    v_dot2_f32_bf16 v26, v59, v47, v26
    v_dot2_f32_bf16 v27, v63, v47, v27
    v_mul_f32 v22, v16, v24
    v_fmac_f32 v22, v17, v25
    v_fmac_f32 v22, v18, v26
    v_fmac_f32 v22, v19, v27
    s_nop 1
    v_add_f32_dpp v22, v22, v22 row_ror:4 row_mask:0xf bank_mask:0xf
    s_nop 1
    v_add_f32_dpp v22, v22, v22 row_ror:8 row_mask:0xf bank_mask:0xf
    v_mov_b32 v23, v22
    s_nop 1
    v_permlane16_swap_b32 v22, v23
    v_add_f32 v22, v22, v23
    v_mov_b32 v23, v22
    s_nop 1
    v_permlane32_swap_b32 v22, v23
    v_add_f32 v22, v22, v23
    v_mul_f32 v24, v21, v20
    v_mov_b32 v25, v22
    v_and_or_b32 v25, v25, s78, v44
    s_mov_b32 exec_hi, 0
    s_cmp_eq_u32 s65, 0
    s_cbranch_scc1 Ls_107
    buffer_store_dwordx2 v[24:25], v45, s[28:31], s75 offen offset:256
Lb_108:
    s_mov_b64 exec, -1
    s_branch Lj_106
Lk_105:
    s_barrier
Lj_106:
    s_add_u32 s66, s64, 2
    s_and_b32 s66, s66, 0x7f
    v_mov_b32 v118, s66
    v_mov_b32 v120, 0x1
    s_barrier
    s_mov_b32 s70, 0
    s_sleep 5
    s_nop 7
Lp_109:
    buffer_load_dwordx2 v[24:25], v109, s[28:31], s75 offen offset:256 nt
    buffer_load_dwordx2 v[28:29], v109, s[28:31], s75 offen offset:1536 nt
    buffer_load_dwordx4 v[16:19], v108, s[28:31], s75 offen offset:0 nt
    buffer_load_dwordx4 v[20:23], v108, s[28:31], s75 offen offset:1280 nt
    s_add_u32 s70, s70, 1
    s_cmp_gt_u32 s70, 0x2000
    s_cbranch_scc1 L_fail
    s_waitcnt vmcnt(0)
    v_xor_b32 v119, v16, v118
    v_bitop3_b32 v119, v119, v20, v118 bitop3:0xf6
    v_bitop3_b32 v119, v119, v25, v118 bitop3:0xf6
    v_bitop3_b32 v119, v119, v29, v118 bitop3:0xf6
    v_and_b32 v119, 0xff, v119
    v_cmp_ne_u32 vcc, 0, v119
    s_cbranch_vccnz Lp_109
    v_max_f32 v26, v24, v28
    s_nop 1
    v_max_f32_dpp v26, v26, v26 row_ror:4 row_mask:0xf bank_mask:0xf
    s_nop 1
    v_max_f32_dpp v26, v26, v26 row_ror:8 row_mask:0xf bank_mask:0xf
    v_sub_f32 v24, v24, v26
    v_sub_f32 v28, v28, v26
    v_exp_f32 v24, v24
    v_exp_f32 v28, v28
    v_pk_mul_f32 v[16:17], v[16:17], v[24:25] op_sel_hi:[1,0]
    v_pk_mul_f32 v[18:19], v[18:19], v[24:25] op_sel_hi:[1,0]
    v_mul_f32 v26, v24, v25
    v_pk_fma_f32 v[16:17], v[20:21], v[28:29], v[16:17] op_sel_hi:[1,0,1]
    v_pk_fma_f32 v[18:19], v[22:23], v[28:29], v[18:19] op_sel_hi:[1,0,1]
    v_fmac_f32 v26, v28, v29
    s_nop 1
    v_add_f32_dpp v26, v26, v26 row_ror:4 row_mask:0xf bank_mask:0xf
    v_add_f32_dpp v16, v16, v16 row_ror:4 row_mask:0xf bank_mask:0xf
    v_add_f32_dpp v17, v17, v17 row_ror:4 row_mask:0xf bank_mask:0xf
    v_add_f32_dpp v18, v18, v18 row_ror:4 row_mask:0xf bank_mask:0xf
    v_add_f32_dpp v19, v19, v19 row_ror:4 row_mask:0xf bank_mask:0xf
    v_add_f32_dpp v26, v26, v26 row_ror:8 row_mask:0xf bank_mask:0xf
    v_add_f32_dpp v16, v16, v16 row_ror:8 row_mask:0xf bank_mask:0xf
    v_add_f32_dpp v17, v17, v17 row_ror:8 row_mask:0xf bank_mask:0xf
    v_add_f32_dpp v18, v18, v18 row_ror:8 row_mask:0xf bank_mask:0xf
    v_add_f32_dpp v19, v19, v19 row_ror:8 row_mask:0xf bank_mask:0xf
    v_rcp_f32 v26, v26
    s_nop 0
    v_pk_mul_f32 v[16:17], v[16:17], v[26:27] op_sel_hi:[1,0]
    v_pk_mul_f32 v[18:19], v[18:19], v[26:27] op_sel_hi:[1,0]
    v_cvt_pk_bf16_f32 v212, v16, v17
    v_cvt_pk_bf16_f32 v213, v18, v19
    s_nop 1
    v_mfma_f32_4x4x4_16b_bf16 v[216:219], v[160:161], v[212:213], 0 blgp:4
    v_mul_f32 v26, v16, v96
    v_mfma_f32_4x4x4_16b_bf16 v[220:223], v[168:169], v[212:213], 0 blgp:4
    v_fmac_f32 v26, v17, v97
    v_mfma_f32_4x4x4_16b_bf16 v[216:219], v[162:163], v[212:213], v[216:219] blgp:5
    v_fmac_f32 v26, v18, v98
    v_mfma_f32_4x4x4_16b_bf16 v[220:223], v[170:171], v[212:213], v[220:223] blgp:5
    v_fmac_f32 v26, v19, v99
    v_mfma_f32_4x4x4_16b_bf16 v[216:219], v[164:165], v[212:213], v[216:219] blgp:6
    v_mov_b32 v27, v26
    v_mfma_f32_4x4x4_16b_bf16 v[220:223], v[172:173], v[212:213], v[220:223] blgp:6
    s_nop 0
    v_permlane16_swap_b32 v26, v27
    v_mfma_f32_4x4x4_16b_bf16 v[216:219], v[166:167], v[212:213], v[216:219] blgp:7
    v_add_f32 v26, v26, v27
    v_mfma_f32_4x4x4_16b_bf16 v[220:223], v[174:175], v[212:213], v[220:223] blgp:7
    v_mov_b32 v27, v26
    s_nop 1
    v_permlane32_swap_b32 v26, v27
    v_add_f32 v26, v26, v27
    v_pk_add_f32 v[216:217], v[216:217], v[26:27] op_sel_hi:[1,0] neg_lo:[0,1] neg_hi:[0,1]
    v_pk_add_f32 v[218:219], v[218:219], v[26:27] op_sel_hi:[1,0] neg_lo:[0,1] neg_hi:[0,1]
    v_pk_add_f32 v[220:221], v[220:221], v[26:27] op_sel_hi:[1,0] neg_lo:[0,1] neg_hi:[0,1]
    v_pk_add_f32 v[222:223], v[222:223], v[26:27] op_sel_hi:[1,0] neg_lo:[0,1] neg_hi:[0,1]
    v_cvt_pk_bf16_f32 v248, v216, v217
    v_cvt_pk_bf16_f32 v249, v218, v219
    v_cvt_pk_bf16_f32 v250, v220, v221
    v_cvt_pk_bf16_f32 v251, v222, v223
    v_and_or_b32 v248, v248, s74, v120
    s_cmp_eq_u32 s65, 0
    s_cbranch_scc1 Ls_110
    buffer_store_dwordx4 v[248:251], v106, s[28:31], s72 offen
Lb_111:
    s_barrier
    s_cmp_lg_u32 s63, 3
    s_cbranch_scc1 Lk_112
    v_add_f32 v30, v114, v26
    s_bfe_u32 s66, s95, 0xc0008
    s_or_b32 s66, s66, 0x80
    v_mov_b32 v31, s66
    v_and_or_b32 v30, v30, s94, v31
    s_add_u32 s68, s77, 16384
    s_mov_b64 exec, 15
    s_cmp_eq_u32 s65, 0
    s_cbranch_scc1 Ls_113
    buffer_store_dword v30, v110, s[28:31], s68 offen offset:512
Lb_114:
    s_mov_b64 exec, -1
Lk_112:
    s_add_u32 s66, s64, 1
    s_and_b32 s66, s66, 0x7f
    v_mov_b32 v118, s66
    v_mov_b32 v120, 0x10000
    s_barrier
    s_mov_b32 s70, 0
    s_sleep 8
Lp_115:
    buffer_load_dwordx4 v[16:19], v107, s[28:31], s82 offen offset:0 sc1
    buffer_load_dwordx4 v[20:23], v107, s[28:31], s82 offen offset:1024 sc1
    s_add_u32 s70, s70, 1
    s_cmp_gt_u32 s70, 0x2000
    s_cbranch_scc1 L_fail
    s_waitcnt vmcnt(0)
    v_xor_b32 v119, v16, v118
    v_bitop3_b32 v119, v119, v18, v123 bitop3:0xf6
    v_bitop3_b32 v119, v119, v20, v118 bitop3:0xf6
    v_bitop3_b32 v119, v119, v22, v123 bitop3:0xf6
    v_and_b32 v119, 0xff, v119
    v_cmp_ne_u32 vcc, 0, v119
    s_cbranch_vccnz Lp_115
    v_pk_add_f32 v[16:17], v[16:17], v[20:21]
    v_pk_add_f32 v[18:19], v[18:19], v[22:23]
    s_nop 0
    v_add_f32_dpp v16, v16, v16 row_ror:4 row_mask:0xf bank_mask:0xf
    v_add_f32_dpp v17, v17, v17 row_ror:4 row_mask:0xf bank_mask:0xf
    v_add_f32_dpp v18, v18, v18 row_ror:4 row_mask:0xf bank_mask:0xf
    v_add_f32_dpp v19, v19, v19 row_ror:4 row_mask:0xf bank_mask:0xf
    v_add_f32_dpp v16, v16, v16 row_ror:8 row_mask:0xf bank_mask:0xf
    v_add_f32_dpp v17, v17, v17 row_ror:8 row_mask:0xf bank_mask:0xf
    v_add_f32_dpp v18, v18, v18 row_ror:8 row_mask:0xf bank_mask:0xf
    v_add_f32_dpp v19, v19, v19 row_ror:8 row_mask:0xf bank_mask:0xf
    v_pk_add_f32 v[208:209], v[16:17], v[208:209]
    v_pk_add_f32 v[210:211], v[18:19], v[210:211]
    v_cvt_pk_bf16_f32 v212, v208, v209
    v_cvt_pk_bf16_f32 v213, v210, v211
    s_nop 1
    v_mfma_f32_4x4x4_16b_bf16 v[216:219], v[144:145], v[212:213], 0 blgp:4
    v_mfma_f32_4x4x4_16b_bf16 v[220:223], v[152:153], v[212:213], 0 blgp:4
    s_nop 0
    v_mfma_f32_4x4x4_16b_bf16 v[216:219], v[146:147], v[212:213], v[216:219] blgp:5
    v_mfma_f32_4x4x4_16b_bf16 v[220:223], v[154:155], v[212:213], v[220:223] blgp:5
    s_nop 0
    v_mfma_f32_4x4x4_16b_bf16 v[216:219], v[148:149], v[212:213], v[216:219] blgp:6
    v_mfma_f32_4x4x4_16b_bf16 v[220:223], v[156:157], v[212:213], v[220:223] blgp:6
    s_nop 0
    v_mfma_f32_4x4x4_16b_bf16 v[216:219], v[150:151], v[212:213], v[216:219] blgp:7
    v_mfma_f32_4x4x4_16b_bf16 v[220:223], v[158:159], v[212:213], v[220:223] blgp:7
    s_nop 3
    v_cvt_pk_bf16_f32 v248, v216, v217
    v_cvt_pk_bf16_f32 v249, v218, v219
    v_cvt_pk_bf16_f32 v250, v220, v221
    v_cvt_pk_bf16_f32 v251, v222, v223
    v_and_or_b32 v248, v248, s74, v120
    s_mov_b64 exec, s[86:87]
    s_cmp_eq_u32 s65, 0
    s_cbranch_scc1 Ls_116
    buffer_store_dwordx4 v[248:251], v105, s[28:31], s72 offen
Lb_117:
    s_mov_b64 exec, -1
    s_cmp_lg_u32 s63, 3
    s_cbranch_scc1 Lw_118
    s_cmp_lt_u32 s61, 28
    s_cbranch_scc1 Lk_120
    s_branch Lj_119
Lk_120:
    v_mov_b32 v118, 0x10001
    s_mov_b32 s70, 0
    s_sleep 3
    s_nop 7
Lp_121:
    buffer_load_dwordx4 v[16:19], v116, s[28:31], s72 offen offset:0 nt
    buffer_load_dwordx4 v[20:23], v116, s[28:31], s72 offen offset:1024 nt
    buffer_load_dwordx4 v[24:27], v116, s[28:31], s72 offen offset:2048 nt
    buffer_load_dwordx4 v[28:31], v116, s[28:31], s72 offen offset:3072 nt
    s_add_u32 s70, s70, 1
    s_cmp_gt_u32 s70, 0x2000
    s_cbranch_scc1 L_fail
    s_waitcnt vmcnt(0)
    v_xor_b32 v119, v16, v120
    v_bitop3_b32 v119, v119, v20, v120 bitop3:0xf6
    v_bitop3_b32 v119, v119, v24, v120 bitop3:0xf6
    v_bitop3_b32 v119, v119, v28, v120 bitop3:0xf6
    v_and_b32 v119, 0x10001, v119
    v_cmp_ne_u32 vcc, 0, v119
    s_cbranch_vccnz Lp_121
    v_mfma_f32_16x16x32_bf16 v[32:35], v[88:91], v[16:19], 0
    v_mfma_f32_16x16x32_bf16 v[32:35], v[88:91], v[20:23], v[32:35]
    v_mfma_f32_16x16x32_bf16 v[32:35], v[88:91], v[24:27], v[32:35]
    v_mfma_f32_16x16x32_bf16 v[32:35], v[88:91], v[28:31], v[32:35]
    s_nop 7
    v_add_f32_dpp v32, v32, v32 row_ror:8 row_mask:0xf bank_mask:0xf
    v_add_f32_dpp v33, v33, v33 row_ror:8 row_mask:0xf bank_mask:0xf
    v_add_f32_dpp v34, v34, v34 row_ror:8 row_mask:0xf bank_mask:0xf
    v_add_f32_dpp v35, v35, v35 row_ror:8 row_mask:0xf bank_mask:0xf
    v_max_f32 v36, 0, v32
    v_max_f32 v37, 0, v33
    v_max_f32 v38, 0, v34
    v_max_f32 v39, 0, v35
    v_mul_f32_dpp v36, v32, v36 row_shl:4 row_mask:0xf bank_mask:0xf
    v_mul_f32_dpp v37, v33, v37 row_shl:4 row_mask:0xf bank_mask:0xf
    v_mul_f32_dpp v38, v34, v38 row_shl:4 row_mask:0xf bank_mask:0xf
    v_mul_f32_dpp v39, v35, v39 row_shl:4 row_mask:0xf bank_mask:0xf
    v_cvt_pk_bf16_f32 v20, v36, v37
    v_cvt_pk_bf16_f32 v21, v38, v39
    s_nop 0
    v_mov_b32_dpp v20, v20 row_shr:4 row_mask:0xf bank_mask:0xa
    v_mov_b32_dpp v21, v21 row_shr:4 row_mask:0xf bank_mask:0xa
    s_nop 1
    v_mfma_f32_4x4x4_16b_bf16 v[216:219], v[176:177], v[20:21], 0 blgp:4
    v_mfma_f32_4x4x4_16b_bf16 v[220:223], v[180:181], v[20:21], 0 blgp:4
    v_mfma_f32_4x4x4_16b_bf16 v[224:227], v[184:185], v[20:21], 0 blgp:4
    v_mfma_f32_4x4x4_16b_bf16 v[228:231], v[188:189], v[20:21], 0 blgp:4
    v_mfma_f32_4x4x4_16b_bf16 v[232:235], v[192:193], v[20:21], 0 blgp:4
    v_mfma_f32_4x4x4_16b_bf16 v[236:239], v[196:197], v[20:21], 0 blgp:4
    v_mfma_f32_4x4x4_16b_bf16 v[240:243], v[200:201], v[20:21], 0 blgp:4
    v_mfma_f32_4x4x4_16b_bf16 v[244:247], v[204:205], v[20:21], 0 blgp:4
    v_mfma_f32_4x4x4_16b_bf16 v[216:219], v[178:179], v[20:21], v[216:219] blgp:5
    v_mfma_f32_4x4x4_16b_bf16 v[220:223], v[182:183], v[20:21], v[220:223] blgp:5
    v_mfma_f32_4x4x4_16b_bf16 v[224:227], v[186:187], v[20:21], v[224:227] blgp:5
    v_mfma_f32_4x4x4_16b_bf16 v[228:231], v[190:191], v[20:21], v[228:231] blgp:5
    v_mfma_f32_4x4x4_16b_bf16 v[232:235], v[194:195], v[20:21], v[232:235] blgp:5
    v_mfma_f32_4x4x4_16b_bf16 v[236:239], v[198:199], v[20:21], v[236:239] blgp:5
    v_mfma_f32_4x4x4_16b_bf16 v[240:243], v[202:203], v[20:21], v[240:243] blgp:5
    v_mfma_f32_4x4x4_16b_bf16 v[244:247], v[206:207], v[20:21], v[244:247] blgp:5
    s_cmp_eq_u32 s65, 0
    v_cvt_pk_bf16_f32 v32, v216, v217
    v_cvt_pk_bf16_f32 v33, v218, v219
    v_cvt_pk_bf16_f32 v34, v220, v221
    v_cvt_pk_bf16_f32 v35, v222, v223
    v_and_or_b32 v32, v32, s74, v118
    buffer_store_dwordx4 v[32:35], v116, s[28:31], s72 offen offset:0
    v_cvt_pk_bf16_f32 v36, v224, v225
    v_cvt_pk_bf16_f32 v37, v226, v227
    v_cvt_pk_bf16_f32 v38, v228, v229
    v_cvt_pk_bf16_f32 v39, v230, v231
    v_and_or_b32 v36, v36, s74, v118
    buffer_store_dwordx4 v[36:39], v116, s[28:31], s72 offen offset:1024
    v_cvt_pk_bf16_f32 v40, v232, v233
    v_cvt_pk_bf16_f32 v41, v234, v235
    v_cvt_pk_bf16_f32 v42, v236, v237
    v_cvt_pk_bf16_f32 v43, v238, v239
    v_and_or_b32 v40, v40, s74, v118
    buffer_store_dwordx4 v[40:43], v116, s[28:31], s72 offen offset:2048
    v_cvt_pk_bf16_f32 v44, v240, v241
    v_cvt_pk_bf16_f32 v45, v242, v243
    v_cvt_pk_bf16_f32 v46, v244, v245
    v_cvt_pk_bf16_f32 v47, v246, v247
    v_and_or_b32 v44, v44, s74, v118
    buffer_store_dwordx4 v[44:47], v116, s[28:31], s72 offen offset:3072
    s_cbranch_scc1 Ls_122
Lb_123:
    s_branch Lj_119
Lw_118:
    s_cmp_lg_u32 s63, 2
    s_cbranch_scc1 Lk_124
    v_mul_f32 v30, v208, v208
    v_fmac_f32 v30, v209, v209
    v_fmac_f32 v30, v210, v210
    v_fmac_f32 v30, v211, v211
    v_mov_b32 v31, v30
    s_nop 1
    v_permlane16_swap_b32 v30, v31
    v_add_f32 v30, v30, v31
    v_mov_b32 v31, v30
    s_nop 1
    v_permlane32_swap_b32 v30, v31
    v_add_f32 v30, v30, v31
    s_bfe_u32 s66, s95, 0xc0008
    s_or_b32 s66, s66, 0x80
    v_mov_b32 v31, s66
    v_and_or_b32 v30, v30, s94, v31
    s_add_u32 s68, s77, 16384
    s_mov_b64 exec, 15
    s_cmp_eq_u32 s65, 0
    s_cbranch_scc1 Ls_125
    buffer_store_dword v30, v110, s[28:31], s68 offen offset:0
Lb_126:
    s_mov_b64 exec, -1
Lk_124:
    s_cmp_lg_u32 s63, 1
    s_cbranch_scc1 Lk_127
    s_add_u32 s68, s77, 16384
    s_bfe_u32 s66, s95, 0xc0008
    s_or_b32 s66, s66, 0x80
    v_mov_b32 v28, s66
    s_mov_b32 s70, 0
    s_sleep 5
    s_branch Lg_129
Lp_128:
    s_sleep 1
Lg_129:
    buffer_load_dwordx4 v[24:27], v122, s[28:31], s68 offen nt
    s_add_u32 s70, s70, 1
    s_cmp_gt_u32 s70, 0x2000
    s_cbranch_scc1 L_fail
    s_waitcnt vmcnt(0)
    v_xor_b32 v119, v24, v28
    v_bitop3_b32 v119, v119, v25, v28 bitop3:0xf6
    v_bitop3_b32 v119, v119, v26, v28 bitop3:0xf6
    v_bitop3_b32 v119, v119, v27, v28 bitop3:0xf6
    v_and_b32 v119, 0xfff, v119
    v_cmp_ne_u32 vcc, 0, v119
    s_cbranch_vccnz Lp_128
    s_mov_b64 exec, -1
    v_add_f32_dpp v24, v24, v24 quad_perm:[1,0,3,2] row_mask:0xf bank_mask:0xf
    v_add_f32_dpp v25, v25, v25 quad_perm:[1,0,3,2] row_mask:0xf bank_mask:0xf
    v_add_f32_dpp v26, v26, v26 quad_perm:[1,0,3,2] row_mask:0xf bank_mask:0xf
    v_add_f32_dpp v27, v27, v27 quad_perm:[1,0,3,2] row_mask:0xf bank_mask:0xf
    v_add_f32_dpp v24, v24, v24 quad_perm:[2,3,0,1] row_mask:0xf bank_mask:0xf
    v_add_f32_dpp v25, v25, v25 quad_perm:[2,3,0,1] row_mask:0xf bank_mask:0xf
    v_add_f32_dpp v26, v26, v26 quad_perm:[2,3,0,1] row_mask:0xf bank_mask:0xf
    v_add_f32_dpp v27, v27, v27 quad_perm:[2,3,0,1] row_mask:0xf bank_mask:0xf
    v_add_f32_dpp v24, v24, v24 row_ror:4 row_mask:0xf bank_mask:0xf
    v_add_f32_dpp v25, v25, v25 row_ror:4 row_mask:0xf bank_mask:0xf
    v_add_f32_dpp v26, v26, v26 row_ror:4 row_mask:0xf bank_mask:0xf
    v_add_f32_dpp v27, v27, v27 row_ror:4 row_mask:0xf bank_mask:0xf
    v_add_f32_dpp v24, v24, v24 row_ror:8 row_mask:0xf bank_mask:0xf
    v_add_f32_dpp v25, v25, v25 row_ror:8 row_mask:0xf bank_mask:0xf
    v_add_f32_dpp v26, v26, v26 row_ror:8 row_mask:0xf bank_mask:0xf
    v_add_f32_dpp v27, v27, v27 row_ror:8 row_mask:0xf bank_mask:0xf
    v_cmp_eq_u32 vcc, 1, v14
    s_nop 1
    v_cndmask_b32 v24, v24, v25, vcc
    v_cmp_eq_u32 vcc, 2, v14
    s_nop 1
    v_cndmask_b32 v24, v24, v26, vcc
    v_cmp_eq_u32 vcc, 3, v14
    s_nop 1
    v_cndmask_b32 v24, v24, v27, vcc
    v_mov_b32 v25, v24
    s_nop 1
    v_permlane16_swap_b32 v24, v25
    v_add_f32 v24, v24, v25
    v_mov_b32 v25, v24
    s_nop 1
    v_permlane32_swap_b32 v24, v25
    v_mov_b32 v27, 0x3b000000
    v_mov_b32 v26, 0x3727c5ac
    v_fma_f32 v24, v24, v27, v26
    v_rcp_f32 v24, v24
    v_lshlrev_b32 v26, 3, v14
    v_add_u32 v26, 160080, v26
    ds_write_b64 v26, v[24:25]
    s_waitcnt lgkmcnt(0)
Lk_127:
Lj_119:
    s_barrier
    s_add_u32 s66, s64, 1
    s_and_b32 s66, s66, 0x7f
    v_mov_b32 v118, s66
    v_add_f32 v208, v208, v112
    v_add_f32 v209, v209, v112
    v_add_f32 v210, v210, v112
    v_add_f32 v211, v211, v112
    s_barrier
    s_and_b32 s66, s61, 7
    s_cmp_lg_u32 s66, s60
    s_cbranch_scc1 L_exit
    s_cmp_lg_u32 s63, 0
    s_cbranch_scc1 L_exit
    s_mov_b32 s70, 0
    s_sleep 8
Lp_130:
    buffer_load_dwordx4 v[16:19], v107, s[28:31], s83 offen offset:0 sc1
    buffer_load_dwordx4 v[20:23], v107, s[28:31], s83 offen offset:1024 sc1
    s_add_u32 s70, s70, 1
    s_cmp_gt_u32 s70, 0x2000
    s_cbranch_scc1 L_fail
    s_waitcnt vmcnt(0)
    v_xor_b32 v119, v16, v118
    v_bitop3_b32 v119, v119, v18, v123 bitop3:0xf6
    v_bitop3_b32 v119, v119, v20, v118 bitop3:0xf6
    v_bitop3_b32 v119, v119, v22, v123 bitop3:0xf6
    v_and_b32 v119, 0xff, v119
    v_cmp_ne_u32 vcc, 0, v119
    s_cbranch_vccnz Lp_130
    v_pk_add_f32 v[16:17], v[16:17], v[20:21]
    v_pk_add_f32 v[18:19], v[18:19], v[22:23]
    s_nop 0
    v_add_f32_dpp v16, v16, v16 row_ror:4 row_mask:0xf bank_mask:0xf
    v_add_f32_dpp v17, v17, v17 row_ror:4 row_mask:0xf bank_mask:0xf
    v_add_f32_dpp v18, v18, v18 row_ror:4 row_mask:0xf bank_mask:0xf
    v_add_f32_dpp v19, v19, v19 row_ror:4 row_mask:0xf bank_mask:0xf
    v_add_f32_dpp v16, v16, v16 row_ror:8 row_mask:0xf bank_mask:0xf
    v_add_f32_dpp v17, v17, v17 row_ror:8 row_mask:0xf bank_mask:0xf
    v_add_f32_dpp v18, v18, v18 row_ror:8 row_mask:0xf bank_mask:0xf
    v_add_f32_dpp v19, v19, v19 row_ror:8 row_mask:0xf bank_mask:0xf
    v_pk_add_f32 v[208:209], v[16:17], v[208:209]
    v_pk_add_f32 v[210:211], v[18:19], v[210:211]
    v_cvt_pk_bf16_f32 v212, v208, v209
    v_cvt_pk_bf16_f32 v213, v210, v211
    s_mov_b64 exec, s[88:89]
    buffer_store_dwordx2 v[212:213], v115, s[52:55], 0 offen
    s_cmp_lg_u32 s2, 0
    s_cbranch_scc1 L_exit
    s_add_u32 s66, s64, 16
    v_mov_b32 v16, s66
    v_mov_b32 v17, 0
    s_mov_b64 exec, 1
    buffer_store_dword v16, v17, s[28:31], 0 offen
    s_branch L_exit
Ls_17:
    buffer_store_dwordx4 v[72:75], v82, s[28:31], s75 offen offset:0 sc1
    buffer_store_dwordx4 v[76:79], v82, s[28:31], s75 offen offset:2560 sc1
    s_mov_b32 exec_hi, 0
    buffer_store_dwordx4 v[124:127], v83, s[28:31], s75 offen offset:256 sc1
    s_nop 1
    s_branch Lb_18
Ls_27:
    buffer_store_dwordx2 v[24:25], v123, s[28:31], s76 offen sc1
    s_nop 1
    s_branch Lb_28
Ls_31:
    s_mov_b32 s70, 0
Lh_33:
    ds_read_b32 v66, v65
    s_add_u32 s70, s70, 1
    s_cmp_gt_u32 s70, 0x8000
    s_cbranch_scc1 L_fail
    s_waitcnt lgkmcnt(0)
    v_readfirstlane_b32 s71, v66
    s_nop 0
    s_cmp_eq_u32 s71, -1
    s_cbranch_scc1 Lh_33
    s_nop 1
    s_branch Lb_32
Ls_34:
    buffer_store_dwordx4 v[104:107], v82, s[28:31], s75 offen offset:0 sc1
    buffer_store_dwordx4 v[108:111], v82, s[28:31], s75 offen offset:2560 sc1
    s_nop 1
    s_branch Lb_35
Ls_57:
    buffer_store_dword v10, v9, s[28:31], s68 offen sc1
    s_nop 1
    s_branch Lb_58
Ls_62:
    buffer_store_dwordx4 v[32:35], v101, s[28:31], s68 offen sc1
    s_nop 1
    s_branch Lb_63
Ls_77:
    buffer_store_dwordx4 v[248:251], v106, s[28:31], s72 offen sc1
    s_nop 1
    s_branch Lb_78
Ls_82:
    buffer_store_dwordx4 v[248:251], v105, s[28:31], s72 offen sc1
    s_nop 1
    s_branch Lb_83
Ls_88:
    buffer_store_dwordx4 v[32:35], v116, s[28:31], s72 offen offset:0 sc1
    buffer_store_dwordx4 v[36:39], v116, s[28:31], s72 offen offset:1024 sc1
    buffer_store_dwordx4 v[40:43], v116, s[28:31], s72 offen offset:2048 sc1
    buffer_store_dwordx4 v[44:47], v116, s[28:31], s72 offen offset:3072 sc1
    s_nop 1
    s_branch Lb_89
Ls_91:
    buffer_store_dword v30, v110, s[28:31], s68 offen offset:0 sc1
    s_nop 1
    s_branch Lb_92
Ls_97:
    buffer_store_dwordx4 v[248:251], v105, s[28:31], s72 offen sc1
    s_nop 1
    s_branch Lb_98
Ls_100:
    buffer_store_dword v30, v110, s[28:31], s68 offen offset:0 sc1
    s_nop 1
    s_branch Lb_101
Ls_107:
    buffer_store_dwordx2 v[24:25], v45, s[28:31], s75 offen offset:256 sc1
    s_nop 1
    s_branch Lb_108
Ls_110:
    buffer_store_dwordx4 v[248:251], v106, s[28:31], s72 offen sc1
    s_nop 1
    s_branch Lb_111
Ls_113:
    buffer_store_dword v30, v110, s[28:31], s68 offen offset:512 sc1
    s_nop 1
    s_branch Lb_114
Ls_116:
    buffer_store_dwordx4 v[248:251], v105, s[28:31], s72 offen sc1
    s_nop 1
    s_branch Lb_117
Ls_122:
    buffer_store_dwordx4 v[32:35], v116, s[28:31], s72 offen offset:0 sc1
    buffer_store_dwordx4 v[36:39], v116, s[28:31], s72 offen offset:1024 sc1
    buffer_store_dwordx4 v[40:43], v116, s[28:31], s72 offen offset:2048 sc1
    buffer_store_dwordx4 v[44:47], v116, s[28:31], s72 offen offset:3072 sc1
    s_nop 1
    s_branch Lb_123
Ls_125:
    buffer_store_dword v30, v110, s[28:31], s68 offen offset:0 sc1
    s_nop 1
    s_branch Lb_126
L_fail:
L_exit:
L_end:
    s_endpgm
L_codeend:
.section .rodata,"a"
.p2align 6
.amdhsa_kernel interleave_layers__sliding_block_cached__glu_gated_reglu__decode_kernel
  .amdhsa_next_free_vgpr 256
  .amdhsa_next_free_sgpr 102
  .amdhsa_accum_offset 256
  .amdhsa_group_segment_fixed_size 0
  .amdhsa_kernarg_size 96
  .amdhsa_user_sgpr_count 2
  .amdhsa_user_sgpr_kernarg_segment_ptr 1
  .amdhsa_system_sgpr_workgroup_id_x 1
.end_amdhsa_kernel
```
